```python
import torch

def _softmax(x, axis=-1):
    return torch.softmax(x, dim=axis)
def _gelu(x):
    return torch.nn.functional.gelu(x, approximate="tanh")
def _silu(x):
    return torch.nn.functional.silu(x)
def _sigmoid(x):
    return torch.sigmoid(x)
def _layernorm(x, axis=-1, eps=1e-5):
    m = x.mean(dim=axis, keepdim=True)
    v = x.var(dim=axis, keepdim=True, unbiased=False)
    return (x - m) / torch.sqrt(v + eps)
def _scatter_add(tgt, idx, src, axis=0):
    return tgt.clone().index_add_(axis, idx, src)
def _segment_sum(src, seg, n):
    out = torch.zeros((n,) + src.shape[1:], dtype=src.dtype)
    return out.index_add_(0, seg, src)
def _pad(x, pw):
    flat = tuple(v for pair in reversed(pw) for v in pair)
    return torch.nn.functional.pad(x, flat)

kernel_name = 'parallel_sum__spectral_fnet__moe_arch_mod__prompt'

def setup_inputs():

    _w = (lambda a: (lambda t: t.to(torch.bfloat16) if t.is_floating_point() else t)(torch.as_tensor(a)))
    def _A_setup():
        B, S, D = 1, 2048, 576
        ns = torch.arange(S)[:, None] * torch.arange(S)[None, :]
        nd = torch.arange(D)[:, None] * torch.arange(D)[None, :]
        Ws_re = torch.cos(-2.0 * torch.pi * ns / S).to(float)
        Ws_im = torch.sin(-2.0 * torch.pi * ns / S).to(float)
        Wd_re = torch.cos(-2.0 * torch.pi * nd / D).to(float)
        Wd_im = torch.sin(-2.0 * torch.pi * nd / D).to(float)
        return {
            "x": _w((lambda *s: torch.randn(*s, dtype=torch.bfloat16) * 0.1)(B, S, D)),
            "dft_seq_re": _w(Ws_re),
            "dft_seq_im": _w(Ws_im),
            "dft_hid_re": _w(Wd_re),
            "dft_hid_im": _w(Wd_im),
        }
    _A_in = _A_setup()

    def _B_setup():
        B, S, D, F, C = 1, 2048, 576, 4608, 1
        return {
            "x": _w((lambda *s: torch.randn(*s, dtype=torch.bfloat16) * 0.1)(B, S, D)),
            "w_r": _w((lambda *s: torch.randn(*s, dtype=torch.bfloat16) * 1.6)(D)),
            "w_gate": _w((lambda *s: torch.randn(*s, dtype=torch.bfloat16) * 0.4)(D, F)),
            "w_up": _w((lambda *s: torch.randn(*s, dtype=torch.bfloat16) * 0.4)(D, F)),
            "w_down": _w((lambda *s: torch.randn(*s, dtype=torch.bfloat16) * 0.4)(F, D)),
        }
    _B_in = _B_setup()

    return {
        "A_x": _A_in["x"],
        "A_dft_seq_re": _A_in["dft_seq_re"],
        "A_dft_seq_im": _A_in["dft_seq_im"],
        "A_dft_hid_re": _A_in["dft_hid_re"],
        "A_dft_hid_im": _A_in["dft_hid_im"],
        "B_x": _B_in["x"],
        "B_w_r": _B_in["w_r"],
        "B_w_gate": _B_in["w_gate"],
        "B_w_up": _B_in["w_up"],
        "B_w_down": _B_in["w_down"],
    }

def reference(A_x, A_dft_seq_re, A_dft_seq_im, A_dft_hid_re, A_dft_hid_im, B_x, B_w_r, B_w_gate, B_w_up, B_w_down):
    def _A_ref(x, dft_seq_re, dft_seq_im, dft_hid_re, dft_hid_im):
        a = torch.einsum("bsd,ed->bse", x, dft_hid_re)
        b = torch.einsum("bsd,ed->bse", x, dft_hid_im)
        y = torch.einsum("ts,bse->bte", dft_seq_re, a) - torch.einsum("ts,bse->bte", dft_seq_im, b)
        return y

    def _B_ref(x, w_r, w_gate, w_up, w_down):
        B, S, D = x.shape
        C = 1
        r = x @ w_r
        idx = torch.argsort(-r, axis=-1)[:, :C]
        idx_e = (lambda x, n, axis: torch.repeat_interleave(x, n, dim=axis))(idx.reshape(B, C, 1), D, axis=2)
        x_sel = (lambda x, i, axis: torch.take_along_dim(x, i, dim=axis))(x, idx_e, axis=1)
        g = _silu(x_sel @ w_gate)
        u = x_sel @ w_up
        y = (g * u) @ w_down
        r_sel = _sigmoid((lambda x, i, axis: torch.take_along_dim(x, i, dim=axis))(r, idx, axis=1))
        y = y * r_sel.reshape(B, C, 1)
        b_off = (torch.arange(B) * S).reshape(B, 1)
        flat_idx = (idx + b_off).reshape(B * C)
        zero = (x * 0.0).reshape(B * S, D)
        upd = _scatter_add(zero, flat_idx, y.reshape(B * C, D), axis=0)
        return x + upd.reshape(B, S, D)

    x = A_x
    xn = _layernorm(x, axis=-1)
    return x + _A_ref(xn, A_dft_seq_re, A_dft_seq_im, A_dft_hid_re, A_dft_hid_im) + _B_ref(xn, B_w_r, B_w_gate, B_w_up, B_w_down)
```

```asm
; @launch grid=(216,1,1) block=(576,1,1) lds=163584
.amdgcn_target "amdgcn-amd-amdhsa--gfx950"
.text
.globl parallel_sum__spectral_fnet__moe_arch_mod__prompt_kernel
.p2align 8
.type parallel_sum__spectral_fnet__moe_arch_mod__prompt_kernel,@function
parallel_sum__spectral_fnet__moe_arch_mod__prompt_kernel:
s_cmp_ge_u32 s2, 216
s_cbranch_scc1 ENDX
s_load_dwordx16 s[4:19], s[0:1], 0
s_load_dwordx8 s[20:27], s[0:1], 64
s_load_dwordx2 s[28:29], s[0:1], 96
v_and_b32 v1, 63, v0
v_lshrrev_b32 v2, 6, v0
s_nop 0
v_readfirstlane_b32 s30, v2
s_waitcnt lgkmcnt(0)
s_mov_b32 s32, s4
s_mov_b32 s33, s5
s_mov_b32 s34, 2359296
s_mov_b32 s35, 0x20000
s_mov_b32 s44, s28
s_mov_b32 s45, s29
s_mov_b32 s46, 3145728
s_mov_b32 s47, 0x20000
s_mov_b32 s48, s26
s_mov_b32 s49, s27
s_mov_b32 s50, 256
s_mov_b32 s51, 0x20000
s_mov_b32 s52, s24
s_mov_b32 s53, s25
s_mov_b32 s54, 2359296
s_mov_b32 s55, 0x20000
s_cmp_ge_u32 s2, 200
s_cbranch_scc1 P2ONLY
s_cmp_ge_u32 s2, 128
s_cbranch_scc1 MOE
P1:
s_and_b32 s73, s2, 7
s_lshr_b32 s74, s2, 4
s_lshl_b32 s74, s74, 3
s_or_b32 s60, s73, s74
s_bfe_u32 s61, s2, 0x10003
s_mov_b32 s62, s2
v_mul_u32_u24 v20, 911, v0
v_lshrrev_b32 v20, 16, v20
v_mul_u32_u24 v21, 72, v20
v_sub_u32 v21, v0, v21
v_lshrrev_b32 v22, 1, v20
v_xor_b32 v21, v21, v22
v_mul_u32_u24 v20, 73728, v20
v_lshlrev_b32 v21, 4, v21
v_add_u32 v20, v20, v21
v_xor_b32 v21, 64, v20
s_mul_i32 s80, s60, 1152
s_add_u32 s81, s80, 589824
s_add_u32 s82, s81, 589824
s_add_u32 s83, s82, 589824
s_lshl_b32 s73, s30, 10
s_add_u32 m0, s73, 0
s_nop 0
buffer_load_dwordx4 v20, s[32:35], s80 offen lds
s_add_u32 m0, s73, 9216
s_nop 0
buffer_load_dwordx4 v21, s[32:35], s81 offen lds
s_add_u32 m0, s73, 18432
s_nop 0
buffer_load_dwordx4 v20, s[32:35], s82 offen lds
s_add_u32 m0, s73, 27648
s_nop 0
buffer_load_dwordx4 v21, s[32:35], s83 offen lds
s_or_b32 s73, s2, s30
s_cmp_lg_u32 s73, 0
s_cbranch_scc1 P1_nn
s_memrealtime s[92:93]
v_mov_b32 v23, 0
s_waitcnt lgkmcnt(0)
s_or_b32 s73, s92, 1
v_mov_b32 v22, s73
s_mov_b64 exec, 1
buffer_store_dword v22, v23, s[48:51], 0 offen sc1
s_mov_b64 exec, -1
P1_nn:
s_mov_b32 s56, s16
s_mov_b32 s57, s17
s_mov_b32 s58, 1152
s_mov_b32 s59, 0x20000
v_lshrrev_b32 v17, 4, v1
v_and_b32 v18, 15, v1
s_lshl_b32 s73, s30, 1
v_lshrrev_b32 v22, 1, v17
v_mul_u32_u24 v23, 34, v22
v_add_u32 v24, s73, v17
v_add_u32 v25, v24, v23
v_add_u32 v26, v17, v23
v_add_u32 v26, 34, v26
v_subrev_u32 v26, s73, v26
v_cmp_eq_u32 vcc, 1, v18
v_lshlrev_b32 v27, 4, v25
v_lshlrev_b32 v28, 4, v26
v_mov_b32 v29, 0x10000
v_cndmask_b32 v27, v29, v27, vcc
v_cndmask_b32 v28, v29, v28, vcc
buffer_load_dwordx4 v[48:51], v27, s[56:59], 0 offen
buffer_load_dwordx4 v[52:55], v28, s[56:59], 0 offen
s_barrier
s_mov_b32 s36, s10
s_mov_b32 s37, s11
s_mov_b32 s38, 663552
s_mov_b32 s39, 0x20000
s_mov_b32 s40, s12
s_mov_b32 s41, s13
s_mov_b32 s42, 663552
s_mov_b32 s43, 0x20000
v_lshrrev_b32 v30, 2, v1
v_lshrrev_b32 v31, 4, v1
v_sub_u32 v31, 0, v31
v_and_b32 v31, 3, v31
v_and_b32 v32, 3, v1
v_xor_b32 v31, v31, v32
v_lshlrev_b32 v31, 4, v31
s_lshl_b32 s74, s30, 4
v_add_u32 v30, s74, v30
v_lshlrev_b32 v32, 1, v30
v_add_u32 v32, s61, v32
v_cmp_eq_u32 vcc, 0, v32
v_mov_b32 v33, 288
s_mul_i32 s91, s30, 10240
v_cndmask_b32 v32, v32, v33, vcc
v_mul_u32_u24 v32, 1152, v32
v_add_u32 v32, v32, v31
v_add_u32 v150, 832, v32
s_add_u32 s91, s91, 55296
s_add_u32 m0, s91, 0
s_nop 0
buffer_load_dwordx4 v150, s[36:39], 0 offen offset:0 lds
s_add_u32 m0, s91, 960
s_nop 0
buffer_load_dwordx4 v150, s[36:39], 0 offen offset:64 lds
s_add_u32 m0, s91, 1920
s_nop 0
buffer_load_dwordx4 v150, s[36:39], 0 offen offset:128 lds
s_add_u32 m0, s91, 2880
s_nop 0
buffer_load_dwordx4 v150, s[36:39], 0 offen offset:192 lds
v_lshrrev_b32 v27, 1, v18
v_mul_u32_u24 v28, 1152, v18
v_xor_b32 v40, v24, v27
v_lshl_add_u32 v40, v40, 4, v28
v_add_u32 v29, 36, v24
v_xor_b32 v41, v29, v27
v_lshl_add_u32 v41, v41, 4, v28
v_xor_b32 v42, v26, v27
v_lshl_add_u32 v42, v42, 4, v28
v_xor_b32 v43, v25, v27
v_lshl_add_u32 v43, v43, 4, v28
v_mul_u32_u24 v44, 288, v18
v_lshlrev_b32 v29, 3, v17
v_add_u32 v44, v44, v29
s_lshl_b32 s74, s30, 5
v_add_u32 v44, s74, v44
s_lshl_b32 s74, s30, 7
s_add_u32 s74, s74, 153600
v_lshlrev_b32 v45, 2, v18
v_add_u32 v45, s74, v45
s_add_u32 m0, s91, 3840
s_nop 0
buffer_load_dwordx4 v150, s[36:39], 0 offen offset:256 lds
v_and_b32 v29, 3, v18
v_cmp_eq_u32 s[6:7], 1, v29
v_cmp_eq_u32 s[8:9], 2, v29
v_cmp_eq_u32 s[14:15], 3, v29
v_lshrrev_b32 v29, 2, v18
v_cmp_eq_u32 s[94:95], v29, v17
v_and_b32 v29, 7, v18
v_and_b32 v30, 8, v18
v_sub_u32 v29, v30, v29
v_add_u32 v29, 8, v29
v_lshlrev_b32 v30, 3, v17
v_sub_u32 v46, v29, v30
s_lshl_b32 s73, s61, 15
s_or_b32 s70, s73, 0x3f80
s_mov_b32 s68, 0x3f80
v_sub_u32 v47, 16, v29
v_and_b32 v30, 1, v17
v_lshlrev_b32 v30, 3, v30
v_sub_u32 v47, v47, v30
s_cmp_eq_u32 s30, 8
s_cselect_b32 s73, 8, 99
v_cmp_eq_u32 vcc, s73, v18
v_mov_b32 v30, 99
v_mov_b32 v31, s68
v_cndmask_b32 v47, v47, v30, vcc
v_cmp_gt_u32 vcc, 2, v17
v_mov_b32 v30, s70
s_nop 0
v_cndmask_b32 v56, v31, v30, vcc
v_xor_b32 v57, 0x8000, v56
s_add_u32 m0, s91, 5120
s_nop 0
buffer_load_dwordx4 v150, s[40:43], 0 offen offset:0 lds
v_subrev_u32 v20, 0, v46
v_lshlrev_b32 v21, 4, v20
v_cmp_gt_u32 vcc, 2, v20
v_lshlrev_b32 v24, v21, s68
v_lshlrev_b32 v28, v21, s70
v_mov_b32 v21, 0
v_cndmask_b32 v24, v21, v24, vcc
v_cndmask_b32 v28, v21, v28, vcc
v_subrev_u32 v20, 2, v46
v_lshlrev_b32 v21, 4, v20
v_cmp_gt_u32 vcc, 2, v20
v_lshlrev_b32 v25, v21, s68
v_lshlrev_b32 v29, v21, s70
v_mov_b32 v21, 0
v_cndmask_b32 v25, v21, v25, vcc
v_cndmask_b32 v29, v21, v29, vcc
v_subrev_u32 v20, 4, v46
v_lshlrev_b32 v21, 4, v20
v_cmp_gt_u32 vcc, 2, v20
v_lshlrev_b32 v26, v21, s68
v_lshlrev_b32 v30, v21, s70
v_mov_b32 v21, 0
v_cndmask_b32 v26, v21, v26, vcc
v_cndmask_b32 v30, v21, v30, vcc
v_subrev_u32 v20, 6, v46
v_lshlrev_b32 v21, 4, v20
v_cmp_gt_u32 vcc, 2, v20
v_lshlrev_b32 v27, v21, s68
v_lshlrev_b32 v31, v21, s70
v_mov_b32 v21, 0
v_cndmask_b32 v27, v21, v27, vcc
v_cndmask_b32 v31, v21, v31, vcc
s_add_u32 m0, s91, 6080
s_nop 0
buffer_load_dwordx4 v150, s[40:43], 0 offen offset:64 lds
v_subrev_u32 v20, 0, v47
v_lshlrev_b32 v21, 4, v20
v_cmp_gt_u32 vcc, 2, v20
v_lshlrev_b32 v32, v21, v56
v_lshlrev_b32 v36, v21, v57
v_mov_b32 v21, 0
v_cndmask_b32 v32, v21, v32, vcc
v_cndmask_b32 v36, v21, v36, vcc
v_subrev_u32 v20, 2, v47
v_lshlrev_b32 v21, 4, v20
v_cmp_gt_u32 vcc, 2, v20
v_lshlrev_b32 v33, v21, v56
v_lshlrev_b32 v37, v21, v57
v_mov_b32 v21, 0
v_cndmask_b32 v33, v21, v33, vcc
v_cndmask_b32 v37, v21, v37, vcc
v_subrev_u32 v20, 4, v47
v_lshlrev_b32 v21, 4, v20
v_cmp_gt_u32 vcc, 2, v20
v_lshlrev_b32 v34, v21, v56
v_lshlrev_b32 v38, v21, v57
v_mov_b32 v21, 0
v_cndmask_b32 v34, v21, v34, vcc
v_cndmask_b32 v38, v21, v38, vcc
v_subrev_u32 v20, 6, v47
v_lshlrev_b32 v21, 4, v20
v_cmp_gt_u32 vcc, 2, v20
v_lshlrev_b32 v35, v21, v56
v_lshlrev_b32 v39, v21, v57
v_mov_b32 v21, 0
v_cndmask_b32 v35, v21, v35, vcc
v_cndmask_b32 v39, v21, v39, vcc
s_add_u32 m0, s91, 7040
s_nop 0
buffer_load_dwordx4 v150, s[40:43], 0 offen offset:128 lds
v_cmp_eq_u32 vcc, 0, v18
v_mov_b32 v20, 0
v_mov_b32 v21, 0x3f803f80
v_cndmask_b32 v60, v20, v21, vcc
v_mov_b32 v56, v21
v_mov_b32 v57, v21
v_mov_b32 v58, v21
v_mov_b32 v59, v21
s_cmp_eq_u32 s30, 0
s_cselect_b32 s73, 2, 99
v_cmp_eq_u32 vcc, s73, v1
s_add_u32 s73, s73, 32
v_mov_b32 v21, s68
v_cndmask_b32 v61, v20, v21, vcc
v_cmp_eq_u32 vcc, s73, v1
v_mov_b32 v21, s70
s_nop 0
v_cndmask_b32 v61, v61, v21, vcc
v_or_b32 v61, v61, v60
s_add_u32 m0, s91, 8000
s_nop 0
buffer_load_dwordx4 v150, s[40:43], 0 offen offset:192 lds
s_cmp_eq_u32 s30, 8
s_cbranch_scc1 P1_mt_skip
v_lshrrev_b32 v20, 2, v0
v_and_b32 v21, 3, v0
v_and_b32 v62, 15, v20
v_lshrrev_b32 v63, 6, v20
v_lshlrev_b32 v63, 4, v63
v_add_u32 v62, v62, v63
v_bfe_u32 v63, v20, 4, 2
v_lshlrev_b32 v63, 2, v63
v_and_b32 v64, 1, v21
v_lshlrev_b32 v64, 1, v64
v_add_u32 v63, v63, v64
v_lshrrev_b32 v64, 1, v21
v_lshlrev_b32 v64, 4, v64
v_add_u32 v63, v63, v64
v_lshlrev_b32 v63, 6, v63
v_add_u32 v63, s60, v63
v_mul_u32_u24 v63, v62, v63
v_lshlrev_b32 v64, 6, v62
v_add_u32 v64, v63, v64
v_and_b32 v63, 2047, v63
v_and_b32 v64, 2047, v64
v_cvt_f32_u32 v63, v63
v_cvt_f32_u32 v64, v64
v_mul_f32 v63, 0x3a000000, v63
v_mul_f32 v64, 0x3a000000, v64
v_cos_f32 v65, v63
v_cos_f32 v66, v64
v_sin_f32 v67, v63
v_sin_f32 v68, v64
s_nop 0
v_cvt_pk_bf16_f32 v65, v65, v66
v_cvt_pk_bf16_f32 v67, v67, v68
v_xor_b32 v68, 0x80008000, v67
v_lshlrev_b32 v20, 4, v20
v_lshlrev_b32 v21, 2, v21
v_add_u32 v20, v20, v21
v_add_u32 v20, 147456, v20
ds_write_b32 v20, v65
ds_write_b32 v20, v67 offset:2048
ds_write_b32 v20, v68 offset:4096
P1_mt_skip:
s_add_u32 m0, s91, 8960
s_nop 0
buffer_load_dwordx4 v150, s[40:43], 0 offen offset:256 lds
s_cmp_lg_u32 s30, 0
s_cbranch_scc1 P1_nl
buffer_load_dword v149, off, s[48:51], 0 sc1
P1_nl:
v_mul_u32_u24 v140, 288, v18
v_lshlrev_b32 v20, 4, v17
v_add_u32 v140, v140, v20
v_lshrrev_b32 v21, 2, v18
v_sub_u32 v21, 0, v21
v_and_b32 v21, 3, v21
v_xor_b32 v141, 3, v17
v_xor_b32 v141, v141, v21
v_lshlrev_b32 v141, 4, v141
v_lshlrev_b32 v22, 6, v18
s_mul_i32 s73, s30, 10240
s_add_u32 s73, s73, 55296
v_add_u32 v22, s73, v22
v_add_u32 v141, v141, v22
v_lshrrev_b32 v142, 1, v17
v_xor_b32 v142, 3, v142
v_xor_b32 v142, v142, v21
v_lshlrev_b32 v142, 4, v142
v_and_b32 v23, 1, v17
v_lshlrev_b32 v23, 3, v23
v_add_u32 v142, v142, v23
v_add_u32 v142, v142, v22
v_mul_u32_u24 v143, 288, v18
v_lshlrev_b32 v23, 3, v17
v_add_u32 v143, v143, v23
v_lshlrev_b32 v144, 4, v17
v_add_u32 v144, 161792, v144
v_and_b32 v145, 31, v1
v_lshrrev_b32 v23, 5, v1
v_mul_u32_u24 v23, 1152, v23
v_lshl_add_u32 v146, v145, 2, v23
v_add_u32 v146, 153600, v146
s_cmp_lg_u32 s30, 0
s_cbranch_scc1 P1_w10
s_waitcnt vmcnt(11) lgkmcnt(0)
s_branch P1_w11
P1_w10:
s_waitcnt vmcnt(10) lgkmcnt(0)
P1_w11:
v_or_b32 v48, v48, v61
v_or_b32 v49, v49, v60
v_or_b32 v50, v50, v60
v_or_b32 v51, v51, v60
v_or_b32 v52, v52, v60
v_or_b32 v53, v53, v60
v_or_b32 v54, v54, v60
v_or_b32 v55, v55, v60
s_barrier
ds_read_b128 v[64:67], v40 offset:0
ds_read_b128 v[68:71], v41 offset:0
ds_read_b128 v[72:75], v42 offset:0
ds_read_b128 v[76:79], v43 offset:0
ds_read_b128 v[80:83], v40 offset:18432
ds_read_b128 v[84:87], v41 offset:18432
ds_read_b128 v[88:91], v42 offset:18432
ds_read_b128 v[92:95], v43 offset:18432
s_waitcnt lgkmcnt(7)
v_mfma_f32_16x16x32_bf16 v[96:99], v[24:27], v[64:67], 0
s_waitcnt lgkmcnt(6)
v_mfma_f32_16x16x32_bf16 v[96:99], v[28:31], v[68:71], v[96:99]
s_waitcnt lgkmcnt(5)
v_mfma_f32_16x16x32_bf16 v[120:123], v[52:55], v[72:75], 0
v_mfma_f32_16x16x32_bf16 v[128:131], v[72:75], v[72:75], 0
v_mfma_f32_16x16x32_bf16 v[104:107], v[32:35], v[72:75], v[96:99]
v_mfma_f32_16x16x32_bf16 v[112:115], v[36:39], v[72:75], v[96:99]
s_waitcnt lgkmcnt(4)
v_mfma_f32_16x16x32_bf16 v[120:123], v[48:51], v[76:79], v[120:123]
v_mfma_f32_16x16x32_bf16 v[128:131], v[76:79], v[76:79], v[128:131]
s_waitcnt lgkmcnt(3)
v_mfma_f32_16x16x32_bf16 v[100:103], v[24:27], v[80:83], 0
s_waitcnt lgkmcnt(2)
v_mfma_f32_16x16x32_bf16 v[100:103], v[28:31], v[84:87], v[100:103]
s_waitcnt lgkmcnt(1)
v_mfma_f32_16x16x32_bf16 v[124:127], v[52:55], v[88:91], 0
v_mfma_f32_16x16x32_bf16 v[132:135], v[88:91], v[88:91], 0
v_mfma_f32_16x16x32_bf16 v[108:111], v[32:35], v[88:91], v[100:103]
v_mfma_f32_16x16x32_bf16 v[116:119], v[36:39], v[88:91], v[100:103]
s_waitcnt lgkmcnt(0)
v_mfma_f32_16x16x32_bf16 v[124:127], v[48:51], v[92:95], v[124:127]
v_mfma_f32_16x16x32_bf16 v[132:135], v[92:95], v[92:95], v[132:135]
v_mfma_f32_16x16x32_bf16 v[136:139], v[48:51], v[56:59], 0
v_mfma_f32_16x16x32_bf16 v[136:139], v[52:55], v[56:59], v[136:139]
v_cvt_pk_bf16_f32 v64, v104, v105
v_cvt_pk_bf16_f32 v65, v106, v107
v_cvt_pk_bf16_f32 v66, v112, v113
v_cvt_pk_bf16_f32 v67, v114, v115
ds_write_b64 v44, v[64:65] offset:36864
ds_write_b64 v44, v[66:67] offset:46080
v_cndmask_b32 v128, v128, v129, s[6:7]
v_cndmask_b32 v128, v128, v130, s[8:9]
v_cndmask_b32 v128, v128, v131, s[14:15]
v_cvt_pk_bf16_f32 v68, v108, v109
v_cvt_pk_bf16_f32 v69, v110, v111
v_cvt_pk_bf16_f32 v70, v116, v117
v_cvt_pk_bf16_f32 v71, v118, v119
ds_write_b64 v44, v[68:69] offset:41472
ds_write_b64 v44, v[70:71] offset:50688
s_nop 1
v_cndmask_b32 v132, v132, v133, s[6:7]
v_cndmask_b32 v132, v132, v134, s[8:9]
v_cndmask_b32 v132, v132, v135, s[14:15]
s_mov_b64 exec, s[94:95]
ds_write_b32 v45, v128 offset:1152
ds_write_b32 v45, v132 offset:1216
s_mov_b64 exec, 0xffff
ds_write_b32 v45, v120
ds_write_b32 v45, v124 offset:64
ds_write_b32 v45, v121 offset:2304
ds_write_b32 v45, v125 offset:2368
s_cmp_lg_u32 s30, 0
s_cbranch_scc1 P1_nu0
v_lshlrev_b32 v20, 2, v18
v_add_u32 v20, 161792, v20
ds_write_b32 v20, v122
ds_write_b32 v20, v126 offset:64
P1_nu0:
s_mov_b64 exec, 1
s_lshl_b32 s73, s30, 2
s_add_u32 s73, s73, 157056
v_mov_b32 v20, s73
ds_write_b32 v20, v137
s_mov_b64 exec, -1
s_cmp_lg_u32 s30, 0
s_cbranch_scc1 P1_nn2
s_waitcnt vmcnt(0)
v_readfirstlane_b32 s65, v149
s_cmp_lg_u32 s65, 0
s_cbranch_scc1 P1_pn_done
v_mov_b32 v20, 0
s_mov_b32 s77, 40000
P1_pn_loop:
buffer_load_dword v21, v20, s[48:51], 0 offen sc1
s_waitcnt vmcnt(0)
v_readfirstlane_b32 s65, v21
s_sub_u32 s77, s77, 1
s_cmp_lg_u32 s65, 0
s_cbranch_scc1 P1_pn_done
s_cmp_lg_u32 s77, 0
s_cbranch_scc1 P1_pn_loop
P1_pn_done:
v_mov_b32 v20, 161920
v_mov_b32 v21, s65
ds_write_b32 v20, v21 offset:8
P1_nn2:
s_waitcnt lgkmcnt(0)
s_barrier
ds_read_b32 v20, v146 offset:0
ds_read_b32 v21, v146 offset:128
ds_read_b32 v22, v146 offset:256
ds_read_b32 v23, v146 offset:384
ds_read_b32 v24, v146 offset:512
ds_read_b32 v25, v146 offset:640
ds_read_b32 v26, v146 offset:768
ds_read_b32 v27, v146 offset:896
ds_read_b32 v28, v146 offset:1024
v_mov_b32 v30, 161920
ds_read_b32 v31, v30 offset:8
ds_read_b128 v[64:67], v144
ds_read_b128 v[68:71], v144 offset:64
s_waitcnt vmcnt(0)
s_waitcnt lgkmcnt(2)
v_readfirstlane_b32 s65, v31
v_add_f32 v20, v20, v21
v_add_f32 v22, v22, v23
v_add_f32 v24, v24, v25
v_add_f32 v26, v26, v27
v_add_f32 v20, v20, v28
v_add_f32 v22, v22, v24
v_add_f32 v20, v20, v26
v_add_f32 v22, v20, v22
v_mov_b32 v23, v22
s_nop 1
v_permlane32_swap_b32 v22, v23
s_nop 1
v_mul_f32 v22, 0x3ae38e39, v22
v_mul_f32 v23, 0x3ae38e39, v23
v_fma_f32 v23, -v22, v22, v23
v_max_f32 v23, 0, v23
v_cvt_pk_bf16_f32 v23, v23, v22
v_and_b32 v22, 0xffff0000, v23
v_lshlrev_b32 v23, 16, v23
v_add_f32 v23, 0x3727c5ac, v23
v_cvt_pk_bf16_f32 v23, v23, v23
v_lshlrev_b32 v23, 16, v23
v_sqrt_f32 v23, v23
s_nop 0
v_cvt_pk_bf16_f32 v23, v23, v23
v_lshlrev_b32 v23, 16, v23
v_rcp_f32 v23, v23
s_mul_i32 s74, s30, 128
s_add_u32 s74, s74, 162048
v_lshlrev_b32 v26, 2, v145
v_add_u32 v26, s74, v26
ds_write_b32 v26, v23
v_lshlrev_b32 v26, 4, v17
v_add_u32 v26, s74, v26
ds_read_b128 v[48:51], v26
ds_read_b128 v[52:55], v26 offset:64
s_cmp_lg_u32 s61, 0
s_cbranch_scc1 P1_nocand
v_add_f32 v28, 1.0, v23
v_mul_f32 v29, v22, v23
v_sub_f32 v29, 0, v29
s_lshl_b32 s73, s30, 14
s_lshl_b32 s74, s60, 8
s_add_u32 s73, s73, s74
s_add_u32 s73, s73, 2359296
v_lshlrev_b32 v27, 3, v145
s_mov_b32 exec_hi, 0
buffer_store_dwordx2 v[28:29], v27, s[44:47], s73 offen sc1
s_mov_b32 exec_hi, -1
s_cmp_lg_u32 s30, 1
s_cbranch_scc1 P1_nocand
v_lshlrev_b32 v26, 2, v145
v_add_u32 v26, 155904, v26
v_mov_b32 v27, 157056
ds_read_b32 v32, v26 offset:0
ds_read_b32 v33, v26 offset:128
ds_read_b32 v34, v26 offset:256
ds_read_b32 v35, v26 offset:384
ds_read_b32 v36, v26 offset:512
ds_read_b32 v37, v26 offset:640
ds_read_b32 v38, v26 offset:768
ds_read_b32 v39, v26 offset:896
ds_read_b32 v40, v26 offset:1024
ds_read_b128 v[56:59], v27
ds_read_b128 v[60:63], v27 offset:16
ds_read_b32 v41, v27 offset:32
s_waitcnt lgkmcnt(0)
v_add_f32 v32, v32, v33
v_add_f32 v34, v34, v35
v_add_f32 v36, v36, v37
v_add_f32 v38, v38, v39
v_add_f32 v32, v32, v40
v_add_f32 v34, v34, v36
v_add_f32 v32, v32, v38
v_add_f32 v24, v32, v34
v_add_f32 v56, v56, v57
v_add_f32 v58, v58, v59
v_add_f32 v60, v60, v61
v_add_f32 v62, v62, v63
v_add_f32 v56, v56, v41
v_add_f32 v58, v58, v60
v_add_f32 v56, v56, v62
v_add_f32 v25, v56, v58
v_fma_f32 v24, -v22, v25, v24
v_mul_f32 v24, v24, v23
v_cvt_pk_bf16_f32 v24, v24, v24
v_and_b32 v24, 0xffff, v24
v_xor_b32 v26, 0xffff, v24
v_or_b32 v27, 0x8000, v24
v_cmp_lt_u32 vcc, 0x7fff, v24
s_nop 1
v_cndmask_b32 v24, v27, v26, vcc
v_lshlrev_b32 v24, 16, v24
v_lshlrev_b32 v26, 11, v145
v_or_b32 v24, v24, v26
s_nop 1
v_max_u32_dpp v24, v24, v24 row_shr:1 row_mask:0xf bank_mask:0xf
s_nop 1
v_max_u32_dpp v24, v24, v24 row_shr:2 row_mask:0xf bank_mask:0xf
s_nop 1
v_max_u32_dpp v24, v24, v24 row_shr:4 row_mask:0xf bank_mask:0xf
s_nop 1
v_max_u32_dpp v24, v24, v24 row_shr:8 row_mask:0xf bank_mask:0xf
s_nop 1
v_readlane_b32 s74, v24, 15
v_readlane_b32 s75, v24, 31
s_max_u32 s74, s74, s75
s_or_b32 s74, s74, s60
s_bfe_u32 s75, s74, 0x5000b
v_lshlrev_b32 v30, 13, v1
v_readlane_b32 s76, v23, s75
v_readlane_b32 s89, v22, s75
s_lshl_b32 s75, s60, 7
s_add_u32 s75, s75, 3014656
v_mov_b32 v24, s65
v_mov_b32 v25, s74
v_mov_b32 v26, s76
v_mov_b32 v27, s89
s_mov_b64 exec, 0xffff
buffer_store_dwordx4 v[24:27], v30, s[44:47], s75 offen sc1
s_mov_b64 exec, -1
P1_nocand:
ds_read_b128 v[80:83], v140 offset:36864
ds_read_b128 v[96:99], v141 offset:4096
ds_read_b128 v[84:87], v140 offset:41472
ds_read_b128 v[88:91], v140 offset:46080
ds_read_b128 v[100:103], v141 offset:9216
ds_read_b128 v[92:95], v140 offset:50688
ds_read_b128 v[104:107], v140 offset:36928
ds_read_b128 v[120:123], v141 offset:3072
ds_read_b128 v[108:111], v140 offset:41536
ds_read_b128 v[112:115], v140 offset:46144
ds_read_b128 v[124:127], v141 offset:8192
ds_read_b128 v[116:119], v140 offset:50752
s_waitcnt lgkmcnt(6)
v_mfma_f32_16x16x32_bf16 v[64:67], v[80:83], v[96:99], v[64:67]
v_mfma_f32_16x16x32_bf16 v[68:71], v[84:87], v[96:99], v[68:71]
v_mfma_f32_16x16x32_bf16 v[72:75], v[88:91], v[100:103], 0
v_mfma_f32_16x16x32_bf16 v[76:79], v[92:95], v[100:103], 0
ds_read_b128 v[80:83], v140 offset:36992
ds_read_b128 v[96:99], v141 offset:2048
ds_read_b128 v[84:87], v140 offset:41600
ds_read_b128 v[88:91], v140 offset:46208
ds_read_b128 v[100:103], v141 offset:7168
ds_read_b128 v[92:95], v140 offset:50816
s_waitcnt lgkmcnt(6)
v_mfma_f32_16x16x32_bf16 v[64:67], v[104:107], v[120:123], v[64:67]
v_mfma_f32_16x16x32_bf16 v[68:71], v[108:111], v[120:123], v[68:71]
v_mfma_f32_16x16x32_bf16 v[72:75], v[112:115], v[124:127], v[72:75]
v_mfma_f32_16x16x32_bf16 v[76:79], v[116:119], v[124:127], v[76:79]
ds_read_b128 v[104:107], v140 offset:37056
ds_read_b128 v[120:123], v141 offset:1024
ds_read_b128 v[108:111], v140 offset:41664
ds_read_b128 v[112:115], v140 offset:46272
ds_read_b128 v[124:127], v141 offset:6144
ds_read_b128 v[116:119], v140 offset:50880
s_waitcnt lgkmcnt(6)
v_mfma_f32_16x16x32_bf16 v[64:67], v[80:83], v[96:99], v[64:67]
v_mfma_f32_16x16x32_bf16 v[68:71], v[84:87], v[96:99], v[68:71]
v_mfma_f32_16x16x32_bf16 v[72:75], v[88:91], v[100:103], v[72:75]
v_mfma_f32_16x16x32_bf16 v[76:79], v[92:95], v[100:103], v[76:79]
ds_read_b64 v[80:81], v143 offset:37120
ds_read_b64 v[96:97], v142
ds_read_b64 v[84:85], v143 offset:41728
ds_read_b64 v[88:89], v143 offset:46336
ds_read_b64 v[100:101], v142 offset:5120
ds_read_b64 v[92:93], v143 offset:50944
s_waitcnt lgkmcnt(6)
v_mfma_f32_16x16x32_bf16 v[64:67], v[104:107], v[120:123], v[64:67]
v_mfma_f32_16x16x32_bf16 v[68:71], v[108:111], v[120:123], v[68:71]
v_mfma_f32_16x16x32_bf16 v[72:75], v[112:115], v[124:127], v[72:75]
v_mfma_f32_16x16x32_bf16 v[76:79], v[116:119], v[124:127], v[76:79]
v_lshlrev_b32 v20, 4, v1
v_add_u32 v20, 147456, v20
s_waitcnt lgkmcnt(0)
v_mfma_f32_16x16x16_bf16 v[64:67], v[80:81], v[96:97], v[64:67]
v_mfma_f32_16x16x16_bf16 v[68:71], v[84:85], v[96:97], v[68:71]
v_mfma_f32_16x16x16_bf16 v[72:75], v[88:89], v[100:101], v[72:75]
v_mfma_f32_16x16x16_bf16 v[76:79], v[92:93], v[100:101], v[76:79]
ds_read_b128 v[128:131], v20
ds_read_b128 v[132:135], v20 offset:1024
ds_read_b128 v[136:139], v20 offset:2048
ds_read_b128 v[140:143], v20 offset:3072
ds_read_b128 v[144:147], v20 offset:4096
ds_read_b128 v[148:151], v20 offset:5120
s_nop 4
v_pk_mul_f32 v[64:65], v[64:65], v[48:49]
v_pk_mul_f32 v[66:67], v[66:67], v[50:51]
v_cvt_pk_bf16_f32 v80, v64, v65
v_cvt_pk_bf16_f32 v81, v66, v67
v_pk_mul_f32 v[68:69], v[68:69], v[52:53]
v_pk_mul_f32 v[70:71], v[70:71], v[54:55]
v_cvt_pk_bf16_f32 v82, v68, v69
v_cvt_pk_bf16_f32 v83, v70, v71
v_pk_mul_f32 v[72:73], v[72:73], v[48:49]
v_pk_mul_f32 v[74:75], v[74:75], v[50:51]
v_cvt_pk_bf16_f32 v84, v72, v73
v_cvt_pk_bf16_f32 v85, v74, v75
v_pk_mul_f32 v[76:77], v[76:77], v[52:53]
v_pk_mul_f32 v[78:79], v[78:79], v[54:55]
v_cvt_pk_bf16_f32 v86, v76, v77
v_cvt_pk_bf16_f32 v87, v78, v79
s_waitcnt lgkmcnt(0)
s_nop 1
v_mfma_f32_16x16x32_bf16 v[64:67], v[80:83], v[128:131], 0
v_mfma_f32_16x16x32_bf16 v[68:71], v[84:87], v[128:131], 0
v_mfma_f32_16x16x32_bf16 v[72:75], v[80:83], v[132:135], 0
v_mfma_f32_16x16x32_bf16 v[76:79], v[84:87], v[132:135], 0
v_mfma_f32_16x16x32_bf16 v[64:67], v[84:87], v[144:147], v[64:67]
v_mfma_f32_16x16x32_bf16 v[68:71], v[80:83], v[136:139], v[68:71]
v_mfma_f32_16x16x32_bf16 v[72:75], v[84:87], v[148:151], v[72:75]
v_mfma_f32_16x16x32_bf16 v[76:79], v[80:83], v[140:143], v[76:79]
s_mul_i32 s73, s30, 10240
s_add_u32 s73, s73, 55296
v_lshlrev_b32 v20, 6, v18
v_lshlrev_b32 v21, 4, v17
v_add_u32 v20, v20, v21
v_add_u32 v20, s73, v20
v_lshlrev_b32 v21, 4, v1
v_add_u32 v21, s73, v21
v_lshrrev_b32 v22, 2, v1
v_mul_u32_u24 v22, 73728, v22
v_and_b32 v23, 3, v1
v_lshlrev_b32 v23, 4, v23
v_add_u32 v22, v22, v23
s_lshl_b32 s74, s30, 13
s_lshl_b32 s75, s61, 12
s_add_u32 s74, s74, s75
s_lshl_b32 s75, s60, 6
s_add_u32 s74, s74, s75
s_add_u32 s75, s74, 1179648
s_nop 2
v_cvt_pk_bf16_f32 v80, v64, v68
v_cvt_pk_bf16_f32 v81, v65, v69
v_cvt_pk_bf16_f32 v82, v66, v70
v_cvt_pk_bf16_f32 v83, v67, v71
v_cvt_pk_bf16_f32 v84, v72, v76
v_cvt_pk_bf16_f32 v85, v73, v77
v_cvt_pk_bf16_f32 v86, v74, v78
v_cvt_pk_bf16_f32 v87, v75, v79
ds_write_b128 v20, v[80:83]
ds_write_b128 v20, v[84:87] offset:1024
s_waitcnt lgkmcnt(0)
ds_read_b128 v[88:91], v21
ds_read_b128 v[92:95], v21 offset:1024
s_waitcnt lgkmcnt(1)
buffer_store_dwordx4 v[88:91], v22, s[44:47], s74 offen sc1
s_waitcnt lgkmcnt(0)
buffer_store_dwordx4 v[92:95], v22, s[44:47], s75 offen sc1
s_mul_i32 s63, s62, 7282
s_lshr_b32 s63, s63, 16
s_mul_i32 s64, s63, 9
s_sub_u32 s64, s62, s64
v_lshrrev_b32 v20, 2, v0
v_and_b32 v21, 3, v0
v_lshrrev_b32 v22, 6, v20
v_and_b32 v23, 63, v20
v_lshlrev_b32 v23, 5, v23
v_add_u32 v23, v23, v22
s_lshl_b32 s73, s63, 1
v_add_u32 v23, s73, v23
v_sub_u32 v24, 2048, v23
v_and_b32 v24, 2047, v24
v_and_b32 v25, 63, v23
v_lshlrev_b32 v25, 8, v25
v_lshrrev_b32 v26, 6, v23
v_lshlrev_b32 v26, 3, v26
v_add_u32 v15, v25, v26
v_and_b32 v25, 63, v24
v_lshlrev_b32 v25, 8, v25
v_lshrrev_b32 v26, 6, v24
v_lshlrev_b32 v26, 3, v26
v_add_u32 v16, v25, v26
v_mul_u32_u24 v25, 1152, v23
v_mul_u32_u24 v26, 1152, v24
v_lshlrev_b32 v21, 4, v21
s_lshl_b32 s73, s64, 6
v_add_u32 v13, v25, v21
v_add_u32 v13, s73, v13
v_sub_u32 v14, v26, v21
s_sub_u32 s74, 1138, s73
v_add_u32 v14, s74, v14
s_cmp_eq_u32 s64, 0
s_cselect_b32 s74, 2, 0
v_cmp_eq_u32 vcc, 0, v21
v_mov_b32 v27, s74
v_mov_b32 v26, 0
v_cndmask_b32 v27, v26, v27, vcc
v_sub_u32 v147, v14, v27
v_mul_u32_u24 v148, 1152, v23
buffer_load_dwordx4 v[4:7], v13, s[32:35], 0 offen
buffer_load_dwordx4 v[8:11], v147, s[32:35], 0 offen
buffer_load_ushort v12, v148, s[32:35], 0 offen offset:576
v_and_b32 v20, 15, v1
s_bfe_u32 s73, s30, 0x10001
s_lshl_b32 s73, s73, 4
v_add_u32 v21, s73, v20
v_lshrrev_b32 v22, 4, v1
v_lshlrev_b32 v22, 3, v22
v_mul_u32_u24 v22, v21, v22
v_cmp_eq_u32 vcc, 0, v21
v_and_b32 v23, 1, v20
v_mul_u32_u24 v23, 0x8000, v23
v_lshl_or_b32 v23, v23, 16, v23
v_and_b32 v24, 63, v22
v_cvt_f32_u32 v24, v24
v_mul_f32 v24, 0x3c800000, v24
v_add_u32 v22, v22, v21
v_cos_f32 v28, v24
v_sin_f32 v36, v24
v_and_b32 v24, 63, v22
v_cvt_f32_u32 v24, v24
v_mul_f32 v24, 0x3c800000, v24
v_add_u32 v22, v22, v21
v_cos_f32 v29, v24
v_sin_f32 v37, v24
v_and_b32 v24, 63, v22
v_cvt_f32_u32 v24, v24
v_mul_f32 v24, 0x3c800000, v24
v_add_u32 v22, v22, v21
v_cos_f32 v30, v24
v_sin_f32 v38, v24
v_and_b32 v24, 63, v22
v_cvt_f32_u32 v24, v24
v_mul_f32 v24, 0x3c800000, v24
v_add_u32 v22, v22, v21
v_cos_f32 v31, v24
v_sin_f32 v39, v24
v_and_b32 v24, 63, v22
v_cvt_f32_u32 v24, v24
v_mul_f32 v24, 0x3c800000, v24
v_add_u32 v22, v22, v21
v_cos_f32 v32, v24
v_sin_f32 v40, v24
v_and_b32 v24, 63, v22
v_cvt_f32_u32 v24, v24
v_mul_f32 v24, 0x3c800000, v24
v_add_u32 v22, v22, v21
v_cos_f32 v33, v24
v_sin_f32 v41, v24
v_and_b32 v24, 63, v22
v_cvt_f32_u32 v24, v24
v_mul_f32 v24, 0x3c800000, v24
v_add_u32 v22, v22, v21
v_cos_f32 v34, v24
v_sin_f32 v42, v24
v_and_b32 v24, 63, v22
v_cvt_f32_u32 v24, v24
v_mul_f32 v24, 0x3c800000, v24
v_add_u32 v22, v22, v21
v_cos_f32 v35, v24
v_sin_f32 v43, v24
v_mov_b32 v24, 1.0
v_mov_b32 v25, -1.0
v_cndmask_b32 v36, v36, v24, vcc
v_cndmask_b32 v37, v37, v25, vcc
v_cndmask_b32 v38, v38, v24, vcc
v_cndmask_b32 v39, v39, v25, vcc
v_cndmask_b32 v40, v40, v24, vcc
v_cndmask_b32 v41, v41, v25, vcc
v_cndmask_b32 v42, v42, v24, vcc
v_cndmask_b32 v43, v43, v25, vcc
v_cvt_pk_bf16_f32 v96, v28, v29
v_cvt_pk_bf16_f32 v104, v36, v37
v_cvt_pk_bf16_f32 v97, v30, v31
v_cvt_pk_bf16_f32 v105, v38, v39
v_cvt_pk_bf16_f32 v98, v32, v33
v_cvt_pk_bf16_f32 v106, v40, v41
v_cvt_pk_bf16_f32 v99, v34, v35
v_cvt_pk_bf16_f32 v107, v42, v43
v_xor_b32 v100, v23, v96
v_xor_b32 v108, v23, v104
v_xor_b32 v101, v23, v97
v_xor_b32 v109, v23, v105
v_xor_b32 v102, v23, v98
v_xor_b32 v110, v23, v106
v_xor_b32 v103, v23, v99
v_xor_b32 v111, v23, v107
s_lshl_b32 s73, s30, 7
s_lshl_b32 s74, s61, 6
s_add_u32 s73, s73, s74
s_add_u32 s73, s73, s60
s_mul_i32 s73, s73, 128
s_add_u32 s73, s73, 2703360
v_mov_b32 v20, s73
v_mov_b32 v21, s65
s_waitcnt vmcnt(3)
s_mov_b64 exec, 1
buffer_store_dword v21, v20, s[44:47], 0 offen sc1
s_mov_b64 exec, -1
s_barrier
s_branch P2_ENTRY
P2ONLY:
s_sub_u32 s62, s2, 72
s_mul_i32 s63, s62, 7282
s_lshr_b32 s63, s63, 16
s_mul_i32 s64, s63, 9
s_sub_u32 s64, s62, s64
v_lshrrev_b32 v20, 2, v0
v_and_b32 v21, 3, v0
v_lshrrev_b32 v22, 6, v20
v_and_b32 v23, 63, v20
v_lshlrev_b32 v23, 5, v23
v_add_u32 v23, v23, v22
s_lshl_b32 s73, s63, 1
v_add_u32 v23, s73, v23
v_sub_u32 v24, 2048, v23
v_and_b32 v24, 2047, v24
v_and_b32 v25, 63, v23
v_lshlrev_b32 v25, 8, v25
v_lshrrev_b32 v26, 6, v23
v_lshlrev_b32 v26, 3, v26
v_add_u32 v15, v25, v26
v_and_b32 v25, 63, v24
v_lshlrev_b32 v25, 8, v25
v_lshrrev_b32 v26, 6, v24
v_lshlrev_b32 v26, 3, v26
v_add_u32 v16, v25, v26
v_mul_u32_u24 v25, 1152, v23
v_mul_u32_u24 v26, 1152, v24
v_lshlrev_b32 v21, 4, v21
s_lshl_b32 s73, s64, 6
v_add_u32 v13, v25, v21
v_add_u32 v13, s73, v13
v_sub_u32 v14, v26, v21
s_sub_u32 s74, 1138, s73
v_add_u32 v14, s74, v14
s_cmp_eq_u32 s64, 0
s_cselect_b32 s74, 2, 0
v_cmp_eq_u32 vcc, 0, v21
v_mov_b32 v27, s74
v_mov_b32 v26, 0
v_cndmask_b32 v27, v26, v27, vcc
v_sub_u32 v147, v14, v27
v_mul_u32_u24 v148, 1152, v23
buffer_load_dwordx4 v[4:7], v13, s[32:35], 0 offen
buffer_load_dwordx4 v[8:11], v147, s[32:35], 0 offen
buffer_load_ushort v12, v148, s[32:35], 0 offen offset:576
s_cmp_lg_u32 s30, 0
s_cbranch_scc1 P2O_nw0
v_mov_b32 v20, 0
s_mov_b32 s77, 40000
P2O_pn_loop:
buffer_load_dword v21, v20, s[48:51], 0 offen sc1
s_waitcnt vmcnt(0)
v_readfirstlane_b32 s65, v21
s_sub_u32 s77, s77, 1
s_cmp_lg_u32 s65, 0
s_cbranch_scc1 P2O_pn_done
s_cmp_lg_u32 s77, 0
s_cbranch_scc1 P2O_pn_loop
P2O_pn_done:
v_mov_b32 v20, 161920
v_mov_b32 v21, s65
ds_write_b32 v20, v21 offset:8
s_waitcnt lgkmcnt(0)
P2O_nw0:
s_barrier
v_mov_b32 v20, 161920
ds_read_b32 v21, v20 offset:8
s_waitcnt lgkmcnt(0)
v_readfirstlane_b32 s65, v21
v_and_b32 v20, 15, v1
s_bfe_u32 s73, s30, 0x10001
s_lshl_b32 s73, s73, 4
v_add_u32 v21, s73, v20
v_lshrrev_b32 v22, 4, v1
v_lshlrev_b32 v22, 3, v22
v_mul_u32_u24 v22, v21, v22
v_cmp_eq_u32 vcc, 0, v21
v_and_b32 v23, 1, v20
v_mul_u32_u24 v23, 0x8000, v23
v_lshl_or_b32 v23, v23, 16, v23
v_and_b32 v24, 63, v22
v_cvt_f32_u32 v24, v24
v_mul_f32 v24, 0x3c800000, v24
v_add_u32 v22, v22, v21
v_cos_f32 v28, v24
v_sin_f32 v36, v24
v_and_b32 v24, 63, v22
v_cvt_f32_u32 v24, v24
v_mul_f32 v24, 0x3c800000, v24
v_add_u32 v22, v22, v21
v_cos_f32 v29, v24
v_sin_f32 v37, v24
v_and_b32 v24, 63, v22
v_cvt_f32_u32 v24, v24
v_mul_f32 v24, 0x3c800000, v24
v_add_u32 v22, v22, v21
v_cos_f32 v30, v24
v_sin_f32 v38, v24
v_and_b32 v24, 63, v22
v_cvt_f32_u32 v24, v24
v_mul_f32 v24, 0x3c800000, v24
v_add_u32 v22, v22, v21
v_cos_f32 v31, v24
v_sin_f32 v39, v24
v_and_b32 v24, 63, v22
v_cvt_f32_u32 v24, v24
v_mul_f32 v24, 0x3c800000, v24
v_add_u32 v22, v22, v21
v_cos_f32 v32, v24
v_sin_f32 v40, v24
v_and_b32 v24, 63, v22
v_cvt_f32_u32 v24, v24
v_mul_f32 v24, 0x3c800000, v24
v_add_u32 v22, v22, v21
v_cos_f32 v33, v24
v_sin_f32 v41, v24
v_and_b32 v24, 63, v22
v_cvt_f32_u32 v24, v24
v_mul_f32 v24, 0x3c800000, v24
v_add_u32 v22, v22, v21
v_cos_f32 v34, v24
v_sin_f32 v42, v24
v_and_b32 v24, 63, v22
v_cvt_f32_u32 v24, v24
v_mul_f32 v24, 0x3c800000, v24
v_add_u32 v22, v22, v21
v_cos_f32 v35, v24
v_sin_f32 v43, v24
v_mov_b32 v24, 1.0
v_mov_b32 v25, -1.0
v_cndmask_b32 v36, v36, v24, vcc
v_cndmask_b32 v37, v37, v25, vcc
v_cndmask_b32 v38, v38, v24, vcc
v_cndmask_b32 v39, v39, v25, vcc
v_cndmask_b32 v40, v40, v24, vcc
v_cndmask_b32 v41, v41, v25, vcc
v_cndmask_b32 v42, v42, v24, vcc
v_cndmask_b32 v43, v43, v25, vcc
v_cvt_pk_bf16_f32 v96, v28, v29
v_cvt_pk_bf16_f32 v104, v36, v37
v_cvt_pk_bf16_f32 v97, v30, v31
v_cvt_pk_bf16_f32 v105, v38, v39
v_cvt_pk_bf16_f32 v98, v32, v33
v_cvt_pk_bf16_f32 v106, v40, v41
v_cvt_pk_bf16_f32 v99, v34, v35
v_cvt_pk_bf16_f32 v107, v42, v43
v_xor_b32 v100, v23, v96
v_xor_b32 v108, v23, v104
v_xor_b32 v101, v23, v97
v_xor_b32 v109, v23, v105
v_xor_b32 v102, v23, v98
v_xor_b32 v110, v23, v106
v_xor_b32 v103, v23, v99
v_xor_b32 v111, v23, v107
P2_ENTRY:
s_cmp_eq_u32 s30, 8
s_cbranch_scc1 P2_w8
s_lshl_b32 s73, s64, 7
s_lshl_b32 s74, s30, 4
s_add_u32 s73, s73, s74
s_mul_i32 s73, s73, 128
s_add_u32 s73, s73, 2703360
v_and_b32 v20, 15, v1
v_mul_u32_u24 v20, 128, v20
v_add_u32 v20, s73, v20
s_mov_b32 s77, 40000
s_mov_b64 exec, 0xffff
P2_f1loop:
buffer_load_dword v22, v20, s[44:47], 0 offen sc1
s_waitcnt vmcnt(0)
v_cmp_ne_u32 vcc, s65, v22
s_sub_u32 s77, s77, 1
s_cbranch_vccz P2_f1done
s_mov_b64 exec, vcc
s_cmp_lg_u32 s77, 0
s_cbranch_scc1 P2_f1loop
P2_f1done:
s_mov_b64 exec, -1
s_mul_i32 s98, s63, 147456
s_lshl_b32 s73, s64, 13
s_add_u32 s98, s98, s73
s_add_u32 s74, s98, 73728
s_lshl_b32 s99, s64, 14
s_add_u32 s99, s99, 2359296
v_lshlrev_b32 v32, 4, v0
buffer_load_dwordx4 v[20:23], v32, s[44:47], s98 offen sc1
buffer_load_dwordx4 v[24:27], v32, s[44:47], s74 offen sc1
v_bfe_u32 v33, v0, 5, 1
v_lshlrev_b32 v33, 5, v33
v_xor_b32 v32, v32, v33
v_lshrrev_b32 v17, 4, v1
v_and_b32 v18, 15, v1
s_and_b32 s73, s30, 1
s_bfe_u32 s74, s30, 0x10001
s_lshr_b32 s75, s30, 2
v_lshrrev_b32 v34, 2, v18
v_lshlrev_b32 v35, 3, v17
v_add_u32 v34, v34, v35
v_lshlrev_b32 v34, 6, v34
v_and_b32 v35, 1, v17
v_xor_b32 v35, s75, v35
v_lshlrev_b32 v35, 5, v35
v_add_u32 v34, v34, v35
v_and_b32 v35, 3, v1
v_lshlrev_b32 v35, 3, v35
v_add_u32 v34, v34, v35
s_lshl_b32 s76, s73, 13
v_add_u32 v34, s76, v34
s_lshl_b32 s76, s74, 4
v_add_u32 v36, s76, v18
v_sub_u32 v37, 64, v36
v_cmp_eq_u32 vcc, 0, v36
s_lshl_b32 s76, s73, 6
v_mov_b32 v38, 32
v_cndmask_b32 v37, v37, v38, vcc
v_add_u32 v36, s76, v36
v_add_u32 v37, s76, v37
v_mul_u32_u24 v36, 144, v36
v_mul_u32_u24 v37, 144, v37
s_lshl_b32 s76, s75, 6
s_add_u32 s76, s76, 16384
v_lshlrev_b32 v38, 4, v17
v_add_u32 v38, s76, v38
v_add_u32 v36, v36, v38
v_add_u32 v37, v37, v38
s_mov_b64 s[84:85], vcc
s_waitcnt vmcnt(1)
ds_write_b128 v32, v[20:23] offset:0
s_waitcnt vmcnt(0)
ds_write_b128 v32, v[24:27] offset:8192
s_waitcnt lgkmcnt(0)
s_barrier
buffer_load_dwordx2 v[28:29], v15, s[44:47], s99 offen sc1
buffer_load_dwordx2 v[30:31], v16, s[44:47], s99 offen sc1
ds_read_b64_tr_b16 v[64:65], v34 offset:0
ds_read_b64_tr_b16 v[66:67], v34 offset:256
ds_read_b64_tr_b16 v[68:69], v34 offset:2048
ds_read_b64_tr_b16 v[70:71], v34 offset:2304
ds_read_b64_tr_b16 v[72:73], v34 offset:4096
ds_read_b64_tr_b16 v[74:75], v34 offset:4352
ds_read_b64_tr_b16 v[76:77], v34 offset:6144
ds_read_b64_tr_b16 v[78:79], v34 offset:6400
s_waitcnt lgkmcnt(6)
v_mfma_f32_16x16x32_bf16 v[80:83], v[64:67], v[96:99], 0
v_mfma_f32_16x16x32_bf16 v[84:87], v[64:67], v[104:107], 0
s_waitcnt lgkmcnt(4)
v_mfma_f32_16x16x32_bf16 v[80:83], v[68:71], v[100:103], v[80:83]
v_mfma_f32_16x16x32_bf16 v[84:87], v[68:71], v[108:111], v[84:87]
s_waitcnt lgkmcnt(2)
v_mfma_f32_16x16x32_bf16 v[88:91], v[72:75], v[96:99], 0
v_mfma_f32_16x16x32_bf16 v[92:95], v[72:75], v[104:107], 0
s_waitcnt lgkmcnt(0)
v_mfma_f32_16x16x32_bf16 v[88:91], v[76:79], v[100:103], v[88:91]
v_mfma_f32_16x16x32_bf16 v[92:95], v[76:79], v[108:111], v[92:95]
s_mov_b64 vcc, s[84:85]
v_mov_b32 v39, 0
s_nop 6
v_cndmask_b32 v85, v85, v39, vcc
v_cndmask_b32 v93, v93, v39, vcc
v_cndmask_b32 v87, v87, v39, vcc
v_cndmask_b32 v95, v95, v39, vcc
v_sub_f32 v40, v80, v85
v_add_f32 v44, v80, v85
v_sub_f32 v41, v88, v93
v_add_f32 v45, v88, v93
v_sub_f32 v42, v82, v87
v_add_f32 v46, v82, v87
v_sub_f32 v43, v90, v95
v_add_f32 v47, v90, v95
v_cndmask_b32 v44, v44, v84, vcc
v_cndmask_b32 v45, v45, v92, vcc
v_cndmask_b32 v46, v46, v86, vcc
v_cndmask_b32 v47, v47, v94, vcc
ds_write_b128 v36, v[40:43]
ds_write_b128 v37, v[44:47]
s_branch P2_G
P2_w8:
s_and_b32 s73, s62, 7
s_or_b32 s73, s73, 8
s_lshl_b32 s73, s73, 13
s_add_u32 s73, s73, 3014656
v_lshlrev_b32 v20, 7, v1
v_add_u32 v20, s73, v20
s_mov_b32 s77, 40000
P2w8_pc_loop:
buffer_load_dwordx2 v[22:23], v20, s[44:47], 0 offen sc1
s_waitcnt vmcnt(0)
v_cmp_ne_u32 vcc, s65, v22
s_sub_u32 s77, s77, 1
s_cbranch_vccz P2w8_pc_done
s_mov_b64 exec, vcc
s_cmp_lg_u32 s77, 0
s_cbranch_scc1 P2w8_pc_loop
P2w8_pc_done:
s_mov_b64 exec, -1
v_mov_b32 v26, v23
s_nop 1
v_max_u32_dpp v26, v26, v26 row_shr:1 row_mask:0xf bank_mask:0xf bound_ctrl:0
s_nop 1
v_max_u32_dpp v26, v26, v26 row_shr:2 row_mask:0xf bank_mask:0xf bound_ctrl:0
s_nop 1
v_max_u32_dpp v26, v26, v26 row_shr:4 row_mask:0xf bank_mask:0xf bound_ctrl:0
s_nop 1
v_max_u32_dpp v26, v26, v26 row_shr:8 row_mask:0xf bank_mask:0xf bound_ctrl:0
s_nop 1
v_readlane_b32 s73, v26, 15
v_readlane_b32 s74, v26, 31
v_readlane_b32 s75, v26, 47
v_readlane_b32 s76, v26, 63
s_max_u32 s73, s73, s74
s_max_u32 s75, s75, s76
s_max_u32 s67, s73, s75
s_bfe_u32 s73, s67, 0x5000b
s_lshl_b32 s73, s73, 6
s_and_b32 s74, s67, 63
s_or_b32 s66, s73, s74
v_mov_b32 v20, 161920
v_mov_b32 v22, s66
v_mov_b32 v23, s67
v_mov_b32 v24, s65
ds_write_b96 v20, v[22:24]
v_lshlrev_b32 v20, 2, v1
v_add_u32 v20, 161984, v20
v_mov_b32 v21, 0
s_mov_b64 exec, 0xff
ds_write_b32 v20, v21
s_mov_b64 exec, -1
s_waitcnt lgkmcnt(0)
s_barrier
s_and_b32 s73, s66, 31
s_lshr_b32 s73, s73, 1
s_sub_u32 s74, 2048, s66
s_and_b32 s74, s74, 31
s_lshr_b32 s74, s74, 1
s_cmp_eq_u32 s73, s63
s_cselect_b32 s94, 1, 0
s_cmp_eq_u32 s74, s63
s_cselect_b32 s95, 1, 0
s_or_b32 s73, s94, s95
s_cmp_eq_u32 s73, 0
s_cbranch_scc1 P2_w8row
s_and_b32 s89, s65, 0xff
s_bfe_u32 s90, s65, 0x80008
s_bfe_u32 s86, s65, 0x80010
s_lshr_b32 s87, s65, 24
s_lshr_b32 s73, s67, 16
s_and_b32 s74, s73, 0x7fff
s_xor_b32 s75, s73, 0xffff
s_bitcmp1_b32 s73, 15
s_cselect_b32 s73, s74, s75
s_lshl_b32 s73, s73, 16
v_mov_b32 v20, s73
v_mul_f32 v20, 0xbfb8aa3b, v20
v_exp_f32 v20, v20
s_nop 0
v_add_f32 v20, 1.0, v20
v_rcp_f32 v20, v20
s_nop 0
v_cvt_pk_bf16_f32 v20, v20, v20
v_lshlrev_b32 v19, 16, v20
v_lshrrev_b32 v21, 3, v1
v_mul_u32_u24 v21, 2432, v21
v_and_b32 v22, 7, v1
v_lshlrev_b32 v22, 4, v22
v_add_u32 v21, v21, v22
v_add_u32 v23, 34816, v22
s_cmp_eq_u32 s94, 0
s_cbranch_scc1 P2_noD
s_cmp_eq_u32 s64, 0
s_cbranch_scc1 P2_DX
s_lshl_b32 s73, s64, 7
s_add_u32 s68, s73, 2506752
s_mov_b32 s77, 40000
P2_winD:
s_mov_b32 s74, s68
buffer_load_dwordx4 v[24:27], v21, s[44:47], s74 offen sc1
s_add_u32 s74, s74, 19456
buffer_load_dwordx4 v[28:31], v21, s[44:47], s74 offen sc1
s_add_u32 s74, s74, 19456
buffer_load_dwordx4 v[32:35], v21, s[44:47], s74 offen sc1
s_add_u32 s74, s74, 19456
buffer_load_dwordx4 v[36:39], v21, s[44:47], s74 offen sc1
s_add_u32 s74, s74, 19456
buffer_load_dwordx4 v[40:43], v21, s[44:47], s74 offen sc1
s_add_u32 s74, s74, 19456
buffer_load_dwordx4 v[44:47], v21, s[44:47], s74 offen sc1
s_add_u32 s74, s74, 19456
buffer_load_dwordx4 v[48:51], v21, s[44:47], s74 offen sc1
s_add_u32 s74, s74, 19456
buffer_load_dwordx4 v[52:55], v21, s[44:47], s74 offen sc1
s_add_u32 s74, s74, 19456
buffer_load_dwordx4 v[56:59], v21, s[44:47], s74 offen sc1
s_waitcnt vmcnt(8)
v_xor_b32 v24, s89, v24
v_xor_b32 v25, s90, v25
v_xor_b32 v26, s86, v26
v_xor_b32 v27, s87, v27
v_or3_b32 v60, v24, v25, v26
v_or_b32 v60, v60, v27
s_waitcnt vmcnt(7)
v_xor_b32 v28, s89, v28
v_xor_b32 v29, s90, v29
v_xor_b32 v30, s86, v30
v_xor_b32 v31, s87, v31
v_or3_b32 v60, v60, v28, v29
v_or3_b32 v60, v60, v30, v31
s_waitcnt vmcnt(6)
v_xor_b32 v32, s89, v32
v_xor_b32 v33, s90, v33
v_xor_b32 v34, s86, v34
v_xor_b32 v35, s87, v35
v_or3_b32 v60, v60, v32, v33
v_or3_b32 v60, v60, v34, v35
s_waitcnt vmcnt(5)
v_xor_b32 v36, s89, v36
v_xor_b32 v37, s90, v37
v_xor_b32 v38, s86, v38
v_xor_b32 v39, s87, v39
v_or3_b32 v60, v60, v36, v37
v_or3_b32 v60, v60, v38, v39
s_waitcnt vmcnt(4)
v_xor_b32 v40, s89, v40
v_xor_b32 v41, s90, v41
v_xor_b32 v42, s86, v42
v_xor_b32 v43, s87, v43
v_or3_b32 v60, v60, v40, v41
v_or3_b32 v60, v60, v42, v43
s_waitcnt vmcnt(3)
v_xor_b32 v44, s89, v44
v_xor_b32 v45, s90, v45
v_xor_b32 v46, s86, v46
v_xor_b32 v47, s87, v47
v_or3_b32 v60, v60, v44, v45
v_or3_b32 v60, v60, v46, v47
s_waitcnt vmcnt(2)
v_xor_b32 v48, s89, v48
v_xor_b32 v49, s90, v49
v_xor_b32 v50, s86, v50
v_xor_b32 v51, s87, v51
v_or3_b32 v60, v60, v48, v49
v_or3_b32 v60, v60, v50, v51
s_waitcnt vmcnt(1)
v_xor_b32 v52, s89, v52
v_xor_b32 v53, s90, v53
v_xor_b32 v54, s86, v54
v_xor_b32 v55, s87, v55
v_or3_b32 v60, v60, v52, v53
v_or3_b32 v60, v60, v54, v55
s_waitcnt vmcnt(0)
v_xor_b32 v56, s89, v56
v_xor_b32 v57, s90, v57
v_xor_b32 v58, s86, v58
v_xor_b32 v59, s87, v59
v_or3_b32 v60, v60, v56, v57
v_or3_b32 v60, v60, v58, v59
v_and_b32 v60, 0xff, v60
v_cmp_ne_u32 vcc, 0, v60
s_sub_u32 s77, s77, 1
s_cbranch_vccz P2_winD_ok
s_mov_b64 exec, vcc
s_cmp_lg_u32 s77, 0
s_cbranch_scc1 P2_winD
P2_winD_ok:
s_mov_b64 exec, -1
v_pk_add_f32 v[24:25], v[24:25], v[28:29]
v_pk_add_f32 v[26:27], v[26:27], v[30:31]
v_pk_add_f32 v[24:25], v[24:25], v[32:33]
v_pk_add_f32 v[26:27], v[26:27], v[34:35]
v_pk_add_f32 v[24:25], v[24:25], v[36:37]
v_pk_add_f32 v[26:27], v[26:27], v[38:39]
v_pk_add_f32 v[24:25], v[24:25], v[40:41]
v_pk_add_f32 v[26:27], v[26:27], v[42:43]
v_pk_add_f32 v[24:25], v[24:25], v[44:45]
v_pk_add_f32 v[26:27], v[26:27], v[46:47]
v_pk_add_f32 v[24:25], v[24:25], v[48:49]
v_pk_add_f32 v[26:27], v[26:27], v[50:51]
v_pk_add_f32 v[24:25], v[24:25], v[52:53]
v_pk_add_f32 v[26:27], v[26:27], v[54:55]
v_pk_add_f32 v[24:25], v[24:25], v[56:57]
v_pk_add_f32 v[26:27], v[26:27], v[58:59]
s_nop 1
v_add_f32_dpp v24, v24, v24 row_ror:8 row_mask:0xf bank_mask:0xf
s_nop 1
v_add_f32_dpp v25, v25, v25 row_ror:8 row_mask:0xf bank_mask:0xf
s_nop 1
v_add_f32_dpp v26, v26, v26 row_ror:8 row_mask:0xf bank_mask:0xf
s_nop 1
v_add_f32_dpp v27, v27, v27 row_ror:8 row_mask:0xf bank_mask:0xf
v_mov_b32 v28, v24
v_mov_b32 v29, v25
v_mov_b32 v30, v26
v_mov_b32 v31, v27
s_nop 1
v_permlane16_swap_b32 v24, v28
v_permlane16_swap_b32 v25, v29
v_permlane16_swap_b32 v26, v30
v_permlane16_swap_b32 v27, v31
s_nop 1
v_add_f32 v24, v24, v28
v_add_f32 v25, v25, v29
v_add_f32 v26, v26, v30
v_add_f32 v27, v27, v31
v_mov_b32 v28, v24
v_mov_b32 v29, v25
v_mov_b32 v30, v26
v_mov_b32 v31, v27
s_nop 1
v_permlane32_swap_b32 v24, v28
v_permlane32_swap_b32 v25, v29
v_permlane32_swap_b32 v26, v30
v_permlane32_swap_b32 v27, v31
s_nop 1
v_add_f32 v24, v24, v28
v_add_f32 v25, v25, v29
v_add_f32 v26, v26, v30
v_add_f32 v27, v27, v31
v_cvt_pk_bf16_f32 v28, v24, v25
v_cvt_pk_bf16_f32 v29, v26, v27
v_lshlrev_b32 v24, 16, v28
v_and_b32 v25, 0xffff0000, v28
v_lshlrev_b32 v26, 16, v29
v_and_b32 v27, 0xffff0000, v29
v_mul_f32 v24, v24, v19
v_mul_f32 v25, v25, v19
v_mul_f32 v26, v26, v19
v_mul_f32 v27, v27, v19
v_cvt_pk_bf16_f32 v28, v24, v25
v_cvt_pk_bf16_f32 v29, v26, v27
v_lshlrev_b32 v24, 16, v28
v_and_b32 v25, 0xffff0000, v28
v_lshlrev_b32 v26, 16, v29
v_and_b32 v27, 0xffff0000, v29
v_mov_b32 v112, v24
v_mov_b32 v113, v25
v_mov_b32 v114, v26
v_mov_b32 v115, v27
s_branch P2_noD
P2_DX:
s_lshl_b32 s73, s64, 7
s_add_u32 s68, s73, 2506752
s_mov_b32 s73, 1152
s_add_u32 s69, s73, 2506752
s_mov_b32 s77, 40000
P2_winDX:
s_mov_b32 s74, s68
buffer_load_dwordx4 v[24:27], v21, s[44:47], s74 offen sc1
s_add_u32 s74, s74, 19456
buffer_load_dwordx4 v[28:31], v21, s[44:47], s74 offen sc1
s_add_u32 s74, s74, 19456
buffer_load_dwordx4 v[32:35], v21, s[44:47], s74 offen sc1
s_add_u32 s74, s74, 19456
buffer_load_dwordx4 v[36:39], v21, s[44:47], s74 offen sc1
s_add_u32 s74, s74, 19456
buffer_load_dwordx4 v[40:43], v21, s[44:47], s74 offen sc1
s_add_u32 s74, s74, 19456
buffer_load_dwordx4 v[44:47], v21, s[44:47], s74 offen sc1
s_add_u32 s74, s74, 19456
buffer_load_dwordx4 v[48:51], v21, s[44:47], s74 offen sc1
s_add_u32 s74, s74, 19456
buffer_load_dwordx4 v[52:55], v21, s[44:47], s74 offen sc1
s_add_u32 s74, s74, 19456
buffer_load_dwordx4 v[56:59], v21, s[44:47], s74 offen sc1
s_mov_b32 s74, s69
buffer_load_dwordx4 v[64:67], v21, s[44:47], s74 offen sc1
s_add_u32 s74, s74, 19456
buffer_load_dwordx4 v[68:71], v21, s[44:47], s74 offen sc1
s_add_u32 s74, s74, 19456
buffer_load_dwordx4 v[72:75], v21, s[44:47], s74 offen sc1
s_add_u32 s74, s74, 19456
buffer_load_dwordx4 v[76:79], v21, s[44:47], s74 offen sc1
s_add_u32 s74, s74, 19456
buffer_load_dwordx4 v[80:83], v21, s[44:47], s74 offen sc1
s_add_u32 s74, s74, 19456
buffer_load_dwordx4 v[84:87], v21, s[44:47], s74 offen sc1
s_add_u32 s74, s74, 19456
buffer_load_dwordx4 v[88:91], v21, s[44:47], s74 offen sc1
s_add_u32 s74, s74, 19456
buffer_load_dwordx4 v[92:95], v21, s[44:47], s74 offen sc1
s_add_u32 s74, s74, 19456
buffer_load_dwordx4 v[96:99], v21, s[44:47], s74 offen sc1
s_waitcnt vmcnt(17)
v_xor_b32 v24, s89, v24
v_xor_b32 v25, s90, v25
v_xor_b32 v26, s86, v26
v_xor_b32 v27, s87, v27
v_or3_b32 v60, v24, v25, v26
v_or_b32 v60, v60, v27
s_waitcnt vmcnt(16)
v_xor_b32 v28, s89, v28
v_xor_b32 v29, s90, v29
v_xor_b32 v30, s86, v30
v_xor_b32 v31, s87, v31
v_or3_b32 v60, v60, v28, v29
v_or3_b32 v60, v60, v30, v31
s_waitcnt vmcnt(15)
v_xor_b32 v32, s89, v32
v_xor_b32 v33, s90, v33
v_xor_b32 v34, s86, v34
v_xor_b32 v35, s87, v35
v_or3_b32 v60, v60, v32, v33
v_or3_b32 v60, v60, v34, v35
s_waitcnt vmcnt(14)
v_xor_b32 v36, s89, v36
v_xor_b32 v37, s90, v37
v_xor_b32 v38, s86, v38
v_xor_b32 v39, s87, v39
v_or3_b32 v60, v60, v36, v37
v_or3_b32 v60, v60, v38, v39
s_waitcnt vmcnt(13)
v_xor_b32 v40, s89, v40
v_xor_b32 v41, s90, v41
v_xor_b32 v42, s86, v42
v_xor_b32 v43, s87, v43
v_or3_b32 v60, v60, v40, v41
v_or3_b32 v60, v60, v42, v43
s_waitcnt vmcnt(12)
v_xor_b32 v44, s89, v44
v_xor_b32 v45, s90, v45
v_xor_b32 v46, s86, v46
v_xor_b32 v47, s87, v47
v_or3_b32 v60, v60, v44, v45
v_or3_b32 v60, v60, v46, v47
s_waitcnt vmcnt(11)
v_xor_b32 v48, s89, v48
v_xor_b32 v49, s90, v49
v_xor_b32 v50, s86, v50
v_xor_b32 v51, s87, v51
v_or3_b32 v60, v60, v48, v49
v_or3_b32 v60, v60, v50, v51
s_waitcnt vmcnt(10)
v_xor_b32 v52, s89, v52
v_xor_b32 v53, s90, v53
v_xor_b32 v54, s86, v54
v_xor_b32 v55, s87, v55
v_or3_b32 v60, v60, v52, v53
v_or3_b32 v60, v60, v54, v55
s_waitcnt vmcnt(9)
v_xor_b32 v56, s89, v56
v_xor_b32 v57, s90, v57
v_xor_b32 v58, s86, v58
v_xor_b32 v59, s87, v59
v_or3_b32 v60, v60, v56, v57
v_or3_b32 v60, v60, v58, v59
s_waitcnt vmcnt(8)
v_xor_b32 v64, s89, v64
v_xor_b32 v65, s90, v65
v_xor_b32 v66, s86, v66
v_xor_b32 v67, s87, v67
v_or3_b32 v60, v60, v64, v65
v_or3_b32 v60, v60, v66, v67
s_waitcnt vmcnt(7)
v_xor_b32 v68, s89, v68
v_xor_b32 v69, s90, v69
v_xor_b32 v70, s86, v70
v_xor_b32 v71, s87, v71
v_or3_b32 v60, v60, v68, v69
v_or3_b32 v60, v60, v70, v71
s_waitcnt vmcnt(6)
v_xor_b32 v72, s89, v72
v_xor_b32 v73, s90, v73
v_xor_b32 v74, s86, v74
v_xor_b32 v75, s87, v75
v_or3_b32 v60, v60, v72, v73
v_or3_b32 v60, v60, v74, v75
s_waitcnt vmcnt(5)
v_xor_b32 v76, s89, v76
v_xor_b32 v77, s90, v77
v_xor_b32 v78, s86, v78
v_xor_b32 v79, s87, v79
v_or3_b32 v60, v60, v76, v77
v_or3_b32 v60, v60, v78, v79
s_waitcnt vmcnt(4)
v_xor_b32 v80, s89, v80
v_xor_b32 v81, s90, v81
v_xor_b32 v82, s86, v82
v_xor_b32 v83, s87, v83
v_or3_b32 v60, v60, v80, v81
v_or3_b32 v60, v60, v82, v83
s_waitcnt vmcnt(3)
v_xor_b32 v84, s89, v84
v_xor_b32 v85, s90, v85
v_xor_b32 v86, s86, v86
v_xor_b32 v87, s87, v87
v_or3_b32 v60, v60, v84, v85
v_or3_b32 v60, v60, v86, v87
s_waitcnt vmcnt(2)
v_xor_b32 v88, s89, v88
v_xor_b32 v89, s90, v89
v_xor_b32 v90, s86, v90
v_xor_b32 v91, s87, v91
v_or3_b32 v60, v60, v88, v89
v_or3_b32 v60, v60, v90, v91
s_waitcnt vmcnt(1)
v_xor_b32 v92, s89, v92
v_xor_b32 v93, s90, v93
v_xor_b32 v94, s86, v94
v_xor_b32 v95, s87, v95
v_or3_b32 v60, v60, v92, v93
v_or3_b32 v60, v60, v94, v95
s_waitcnt vmcnt(0)
v_xor_b32 v96, s89, v96
v_xor_b32 v97, s90, v97
v_xor_b32 v98, s86, v98
v_xor_b32 v99, s87, v99
v_or3_b32 v60, v60, v96, v97
v_or3_b32 v60, v60, v98, v99
v_and_b32 v60, 0xff, v60
v_cmp_ne_u32 vcc, 0, v60
s_sub_u32 s77, s77, 1
s_cbranch_vccz P2_winDX_ok
s_mov_b64 exec, vcc
s_cmp_lg_u32 s77, 0
s_cbranch_scc1 P2_winDX
P2_winDX_ok:
s_mov_b64 exec, -1
v_pk_add_f32 v[24:25], v[24:25], v[28:29]
v_pk_add_f32 v[26:27], v[26:27], v[30:31]
v_pk_add_f32 v[24:25], v[24:25], v[32:33]
v_pk_add_f32 v[26:27], v[26:27], v[34:35]
v_pk_add_f32 v[24:25], v[24:25], v[36:37]
v_pk_add_f32 v[26:27], v[26:27], v[38:39]
v_pk_add_f32 v[24:25], v[24:25], v[40:41]
v_pk_add_f32 v[26:27], v[26:27], v[42:43]
v_pk_add_f32 v[24:25], v[24:25], v[44:45]
v_pk_add_f32 v[26:27], v[26:27], v[46:47]
v_pk_add_f32 v[24:25], v[24:25], v[48:49]
v_pk_add_f32 v[26:27], v[26:27], v[50:51]
v_pk_add_f32 v[24:25], v[24:25], v[52:53]
v_pk_add_f32 v[26:27], v[26:27], v[54:55]
v_pk_add_f32 v[24:25], v[24:25], v[56:57]
v_pk_add_f32 v[26:27], v[26:27], v[58:59]
s_nop 1
v_add_f32_dpp v24, v24, v24 row_ror:8 row_mask:0xf bank_mask:0xf
s_nop 1
v_add_f32_dpp v25, v25, v25 row_ror:8 row_mask:0xf bank_mask:0xf
s_nop 1
v_add_f32_dpp v26, v26, v26 row_ror:8 row_mask:0xf bank_mask:0xf
s_nop 1
v_add_f32_dpp v27, v27, v27 row_ror:8 row_mask:0xf bank_mask:0xf
v_mov_b32 v28, v24
v_mov_b32 v29, v25
v_mov_b32 v30, v26
v_mov_b32 v31, v27
s_nop 1
v_permlane16_swap_b32 v24, v28
v_permlane16_swap_b32 v25, v29
v_permlane16_swap_b32 v26, v30
v_permlane16_swap_b32 v27, v31
s_nop 1
v_add_f32 v24, v24, v28
v_add_f32 v25, v25, v29
v_add_f32 v26, v26, v30
v_add_f32 v27, v27, v31
v_mov_b32 v28, v24
v_mov_b32 v29, v25
v_mov_b32 v30, v26
v_mov_b32 v31, v27
s_nop 1
v_permlane32_swap_b32 v24, v28
v_permlane32_swap_b32 v25, v29
v_permlane32_swap_b32 v26, v30
v_permlane32_swap_b32 v27, v31
s_nop 1
v_add_f32 v24, v24, v28
v_add_f32 v25, v25, v29
v_add_f32 v26, v26, v30
v_add_f32 v27, v27, v31
v_cvt_pk_bf16_f32 v28, v24, v25
v_cvt_pk_bf16_f32 v29, v26, v27
v_lshlrev_b32 v24, 16, v28
v_and_b32 v25, 0xffff0000, v28
v_lshlrev_b32 v26, 16, v29
v_and_b32 v27, 0xffff0000, v29
v_mul_f32 v24, v24, v19
v_mul_f32 v25, v25, v19
v_mul_f32 v26, v26, v19
v_mul_f32 v27, v27, v19
v_cvt_pk_bf16_f32 v28, v24, v25
v_cvt_pk_bf16_f32 v29, v26, v27
v_lshlrev_b32 v24, 16, v28
v_and_b32 v25, 0xffff0000, v28
v_lshlrev_b32 v26, 16, v29
v_and_b32 v27, 0xffff0000, v29
v_mov_b32 v112, v24
v_mov_b32 v113, v25
v_mov_b32 v114, v26
v_mov_b32 v115, v27
v_pk_add_f32 v[64:65], v[64:65], v[68:69]
v_pk_add_f32 v[66:67], v[66:67], v[70:71]
v_pk_add_f32 v[64:65], v[64:65], v[72:73]
v_pk_add_f32 v[66:67], v[66:67], v[74:75]
v_pk_add_f32 v[64:65], v[64:65], v[76:77]
v_pk_add_f32 v[66:67], v[66:67], v[78:79]
v_pk_add_f32 v[64:65], v[64:65], v[80:81]
v_pk_add_f32 v[66:67], v[66:67], v[82:83]
v_pk_add_f32 v[64:65], v[64:65], v[84:85]
v_pk_add_f32 v[66:67], v[66:67], v[86:87]
v_pk_add_f32 v[64:65], v[64:65], v[88:89]
v_pk_add_f32 v[66:67], v[66:67], v[90:91]
v_pk_add_f32 v[64:65], v[64:65], v[92:93]
v_pk_add_f32 v[66:67], v[66:67], v[94:95]
v_pk_add_f32 v[64:65], v[64:65], v[96:97]
v_pk_add_f32 v[66:67], v[66:67], v[98:99]
s_nop 1
v_add_f32_dpp v64, v64, v64 row_ror:8 row_mask:0xf bank_mask:0xf
s_nop 1
v_add_f32_dpp v65, v65, v65 row_ror:8 row_mask:0xf bank_mask:0xf
s_nop 1
v_add_f32_dpp v66, v66, v66 row_ror:8 row_mask:0xf bank_mask:0xf
s_nop 1
v_add_f32_dpp v67, v67, v67 row_ror:8 row_mask:0xf bank_mask:0xf
v_mov_b32 v68, v64
v_mov_b32 v69, v65
v_mov_b32 v70, v66
v_mov_b32 v71, v67
s_nop 1
v_permlane16_swap_b32 v64, v68
v_permlane16_swap_b32 v65, v69
v_permlane16_swap_b32 v66, v70
v_permlane16_swap_b32 v67, v71
s_nop 1
v_add_f32 v64, v64, v68
v_add_f32 v65, v65, v69
v_add_f32 v66, v66, v70
v_add_f32 v67, v67, v71
v_mov_b32 v68, v64
v_mov_b32 v69, v65
v_mov_b32 v70, v66
v_mov_b32 v71, v67
s_nop 1
v_permlane32_swap_b32 v64, v68
v_permlane32_swap_b32 v65, v69
v_permlane32_swap_b32 v66, v70
v_permlane32_swap_b32 v67, v71
s_nop 1
v_add_f32 v64, v64, v68
v_add_f32 v65, v65, v69
v_add_f32 v66, v66, v70
v_add_f32 v67, v67, v71
v_cvt_pk_bf16_f32 v68, v64, v65
v_cvt_pk_bf16_f32 v69, v66, v67
v_lshlrev_b32 v64, 16, v68
v_and_b32 v65, 0xffff0000, v68
v_lshlrev_b32 v66, 16, v69
v_and_b32 v67, 0xffff0000, v69
v_mul_f32 v64, v64, v19
v_mul_f32 v65, v65, v19
v_mul_f32 v66, v66, v19
v_mul_f32 v67, v67, v19
v_cvt_pk_bf16_f32 v68, v64, v65
v_cvt_pk_bf16_f32 v69, v66, v67
v_lshlrev_b32 v64, 16, v68
v_and_b32 v65, 0xffff0000, v68
v_lshlrev_b32 v66, 16, v69
v_and_b32 v67, 0xffff0000, v69
v_mov_b32 v116, v64
v_mov_b32 v117, v65
v_mov_b32 v118, v66
v_mov_b32 v119, v67
P2_noD:
s_cmp_eq_u32 s95, 0
s_cbranch_scc1 P2_w8row
s_lshl_b32 s73, s64, 7
s_sub_u32 s73, 2304, s73
s_add_u32 s68, s73, 2506752
s_mov_b32 s77, 40000
P2_winM:
s_mov_b32 s74, s68
buffer_load_dwordx4 v[24:27], v21, s[44:47], s74 offen sc1
s_add_u32 s74, s74, 19456
buffer_load_dwordx4 v[28:31], v21, s[44:47], s74 offen sc1
s_add_u32 s74, s74, 19456
buffer_load_dwordx4 v[32:35], v21, s[44:47], s74 offen sc1
s_add_u32 s74, s74, 19456
buffer_load_dwordx4 v[36:39], v21, s[44:47], s74 offen sc1
s_add_u32 s74, s74, 19456
buffer_load_dwordx4 v[40:43], v21, s[44:47], s74 offen sc1
s_add_u32 s74, s74, 19456
buffer_load_dwordx4 v[44:47], v21, s[44:47], s74 offen sc1
s_add_u32 s74, s74, 19456
buffer_load_dwordx4 v[48:51], v21, s[44:47], s74 offen sc1
s_add_u32 s74, s74, 19456
buffer_load_dwordx4 v[52:55], v21, s[44:47], s74 offen sc1
s_add_u32 s74, s74, 19456
buffer_load_dwordx4 v[56:59], v21, s[44:47], s74 offen sc1
s_waitcnt vmcnt(8)
v_xor_b32 v24, s89, v24
v_xor_b32 v25, s90, v25
v_xor_b32 v26, s86, v26
v_xor_b32 v27, s87, v27
v_or3_b32 v60, v24, v25, v26
v_or_b32 v60, v60, v27
s_waitcnt vmcnt(7)
v_xor_b32 v28, s89, v28
v_xor_b32 v29, s90, v29
v_xor_b32 v30, s86, v30
v_xor_b32 v31, s87, v31
v_or3_b32 v60, v60, v28, v29
v_or3_b32 v60, v60, v30, v31
s_waitcnt vmcnt(6)
v_xor_b32 v32, s89, v32
v_xor_b32 v33, s90, v33
v_xor_b32 v34, s86, v34
v_xor_b32 v35, s87, v35
v_or3_b32 v60, v60, v32, v33
v_or3_b32 v60, v60, v34, v35
s_waitcnt vmcnt(5)
v_xor_b32 v36, s89, v36
v_xor_b32 v37, s90, v37
v_xor_b32 v38, s86, v38
v_xor_b32 v39, s87, v39
v_or3_b32 v60, v60, v36, v37
v_or3_b32 v60, v60, v38, v39
s_waitcnt vmcnt(4)
v_xor_b32 v40, s89, v40
v_xor_b32 v41, s90, v41
v_xor_b32 v42, s86, v42
v_xor_b32 v43, s87, v43
v_or3_b32 v60, v60, v40, v41
v_or3_b32 v60, v60, v42, v43
s_waitcnt vmcnt(3)
v_xor_b32 v44, s89, v44
v_xor_b32 v45, s90, v45
v_xor_b32 v46, s86, v46
v_xor_b32 v47, s87, v47
v_or3_b32 v60, v60, v44, v45
v_or3_b32 v60, v60, v46, v47
s_waitcnt vmcnt(2)
v_xor_b32 v48, s89, v48
v_xor_b32 v49, s90, v49
v_xor_b32 v50, s86, v50
v_xor_b32 v51, s87, v51
v_or3_b32 v60, v60, v48, v49
v_or3_b32 v60, v60, v50, v51
s_waitcnt vmcnt(1)
v_xor_b32 v52, s89, v52
v_xor_b32 v53, s90, v53
v_xor_b32 v54, s86, v54
v_xor_b32 v55, s87, v55
v_or3_b32 v60, v60, v52, v53
v_or3_b32 v60, v60, v54, v55
s_waitcnt vmcnt(0)
v_xor_b32 v56, s89, v56
v_xor_b32 v57, s90, v57
v_xor_b32 v58, s86, v58
v_xor_b32 v59, s87, v59
v_or3_b32 v60, v60, v56, v57
v_or3_b32 v60, v60, v58, v59
v_and_b32 v60, 0xff, v60
v_cmp_ne_u32 vcc, 0, v60
s_sub_u32 s77, s77, 1
s_cbranch_vccz P2_winM_ok
s_mov_b64 exec, vcc
s_cmp_lg_u32 s77, 0
s_cbranch_scc1 P2_winM
P2_winM_ok:
s_mov_b64 exec, -1
v_pk_add_f32 v[24:25], v[24:25], v[28:29]
v_pk_add_f32 v[26:27], v[26:27], v[30:31]
v_pk_add_f32 v[24:25], v[24:25], v[32:33]
v_pk_add_f32 v[26:27], v[26:27], v[34:35]
v_pk_add_f32 v[24:25], v[24:25], v[36:37]
v_pk_add_f32 v[26:27], v[26:27], v[38:39]
v_pk_add_f32 v[24:25], v[24:25], v[40:41]
v_pk_add_f32 v[26:27], v[26:27], v[42:43]
v_pk_add_f32 v[24:25], v[24:25], v[44:45]
v_pk_add_f32 v[26:27], v[26:27], v[46:47]
v_pk_add_f32 v[24:25], v[24:25], v[48:49]
v_pk_add_f32 v[26:27], v[26:27], v[50:51]
v_pk_add_f32 v[24:25], v[24:25], v[52:53]
v_pk_add_f32 v[26:27], v[26:27], v[54:55]
v_pk_add_f32 v[24:25], v[24:25], v[56:57]
v_pk_add_f32 v[26:27], v[26:27], v[58:59]
s_nop 1
v_add_f32_dpp v24, v24, v24 row_ror:8 row_mask:0xf bank_mask:0xf
s_nop 1
v_add_f32_dpp v25, v25, v25 row_ror:8 row_mask:0xf bank_mask:0xf
s_nop 1
v_add_f32_dpp v26, v26, v26 row_ror:8 row_mask:0xf bank_mask:0xf
s_nop 1
v_add_f32_dpp v27, v27, v27 row_ror:8 row_mask:0xf bank_mask:0xf
v_mov_b32 v28, v24
v_mov_b32 v29, v25
v_mov_b32 v30, v26
v_mov_b32 v31, v27
s_nop 1
v_permlane16_swap_b32 v24, v28
v_permlane16_swap_b32 v25, v29
v_permlane16_swap_b32 v26, v30
v_permlane16_swap_b32 v27, v31
s_nop 1
v_add_f32 v24, v24, v28
v_add_f32 v25, v25, v29
v_add_f32 v26, v26, v30
v_add_f32 v27, v27, v31
v_mov_b32 v28, v24
v_mov_b32 v29, v25
v_mov_b32 v30, v26
v_mov_b32 v31, v27
s_nop 1
v_permlane32_swap_b32 v24, v28
v_permlane32_swap_b32 v25, v29
v_permlane32_swap_b32 v26, v30
v_permlane32_swap_b32 v27, v31
s_nop 1
v_add_f32 v24, v24, v28
v_add_f32 v25, v25, v29
v_add_f32 v26, v26, v30
v_add_f32 v27, v27, v31
v_cvt_pk_bf16_f32 v28, v24, v25
v_cvt_pk_bf16_f32 v29, v26, v27
v_lshlrev_b32 v24, 16, v28
v_and_b32 v25, 0xffff0000, v28
v_lshlrev_b32 v26, 16, v29
v_and_b32 v27, 0xffff0000, v29
v_mul_f32 v24, v24, v19
v_mul_f32 v25, v25, v19
v_mul_f32 v26, v26, v19
v_mul_f32 v27, v27, v19
v_cvt_pk_bf16_f32 v28, v24, v25
v_cvt_pk_bf16_f32 v29, v26, v27
v_lshlrev_b32 v24, 16, v28
v_and_b32 v25, 0xffff0000, v28
v_lshlrev_b32 v26, 16, v29
v_and_b32 v27, 0xffff0000, v29
v_mov_b32 v120, v24
v_mov_b32 v121, v25
v_mov_b32 v122, v26
v_mov_b32 v123, v27
P2_w8row:
s_barrier
s_mul_i32 s73, s66, 1152
s_lshl_b32 s74, s64, 6
v_and_b32 v22, 7, v1
v_lshlrev_b32 v22, 3, v22
s_mov_b64 exec, 0xff
s_cmp_eq_u32 s94, 0
s_cbranch_scc1 P2_r_noD
ds_read_b128 v[24:27], v23
v_mov_b32 v28, 35072
ds_read_b32 v29, v28
s_add_u32 s75, s73, s74
s_waitcnt lgkmcnt(1)
v_pk_add_f32 v[24:25], v[24:25], v[112:113]
v_pk_add_f32 v[26:27], v[26:27], v[114:115]
v_cvt_pk_bf16_f32 v24, v24, v25
v_cvt_pk_bf16_f32 v25, v26, v27
buffer_store_dwordx2 v[24:25], v22, s[52:55], s75 offen sc1
s_cmp_lg_u32 s64, 0
s_cbranch_scc1 P2_r_noD
s_waitcnt lgkmcnt(0)
v_add_f32 v29, v29, v116
v_cvt_pk_bf16_f32 v29, v29, v29
s_mov_b64 exec, 1
buffer_store_short v29, off, s[52:55], s73 offset:576 sc1
s_mov_b64 exec, 0xff
P2_r_noD:
s_cmp_eq_u32 s95, 0
s_cbranch_scc1 P2_r_end
ds_read_b128 v[32:35], v23 offset:128
s_sub_u32 s75, 1090, s74
s_add_u32 s75, s75, s73
s_waitcnt lgkmcnt(0)
v_pk_add_f32 v[32:33], v[32:33], v[120:121]
v_pk_add_f32 v[34:35], v[34:35], v[122:123]
v_cvt_pk_bf16_f32 v32, v32, v33
v_cvt_pk_bf16_f32 v33, v34, v35
buffer_store_short v32, v22, s[52:55], s75 offen sc1
buffer_store_short_d16_hi v32, v22, s[52:55], s75 offen offset:2 sc1
buffer_store_short v33, v22, s[52:55], s75 offen offset:4 sc1
s_cmp_eq_u32 s64, 0
s_cselect_b32 s76, 0x80, 0
s_xor_b32 s76, s76, 0xff
s_mov_b32 exec_lo, s76
buffer_store_short_d16_hi v33, v22, s[52:55], s75 offen offset:6 sc1
P2_r_end:
s_mov_b64 exec, -1
s_branch END
P2_G:
s_lshl_b32 s73, s30, 2
s_add_u32 s73, s73, 161984
v_mov_b32 v20, s73
v_mov_b32 v21, 1
v_and_b32 v22, 7, v1
v_lshlrev_b32 v22, 2, v22
v_add_u32 v22, 161984, v22
s_mov_b32 s77, 40000
s_waitcnt lgkmcnt(0)
s_mov_b64 exec, 1
ds_write_b32 v20, v21
s_mov_b64 exec, -1
P2_Gspin:
ds_read_b32 v23, v22
s_sub_u32 s77, s77, 1
s_waitcnt lgkmcnt(0)
v_cmp_ne_u32 vcc, 1, v23
s_cbranch_vccz P2_Gok
s_cmp_lg_u32 s77, 0
s_cbranch_scc1 P2_Gspin
P2_Gok:
v_mov_b32 v20, 161920
ds_read_b96 v[22:24], v20
s_waitcnt lgkmcnt(0)
v_readfirstlane_b32 s66, v22
v_readfirstlane_b32 s67, v23
v_readfirstlane_b32 s65, v24
v_lshrrev_b32 v20, 2, v0
v_and_b32 v21, 3, v0
v_mul_u32_u24 v22, 144, v20
v_lshlrev_b32 v23, 5, v21
v_add_u32 v22, v22, v23
ds_read_b128 v[32:35], v22 offset:16384
ds_read_b128 v[36:39], v22 offset:16400
s_waitcnt vmcnt(0)
s_cmp_lg_u32 s64, 0
s_cbranch_scc1 P2_nofix
v_cmp_eq_u32 vcc, 0, v21
s_and_saveexec_b64 s[84:85], vcc
v_alignbit_b32 v8, v9, v8, 16
v_alignbit_b32 v9, v10, v9, 16
v_alignbit_b32 v10, v11, v10, 16
v_lshrrev_b32 v11, 16, v11
s_mov_b64 exec, s[84:85]
P2_nofix:
v_lshlrev_b32 v40, 16, v4
v_and_b32 v41, 0xffff0000, v4
v_lshlrev_b32 v48, 16, v8
v_and_b32 v49, 0xffff0000, v8
v_lshlrev_b32 v42, 16, v5
v_and_b32 v43, 0xffff0000, v5
v_lshlrev_b32 v50, 16, v9
v_and_b32 v51, 0xffff0000, v9
v_lshlrev_b32 v44, 16, v6
v_and_b32 v45, 0xffff0000, v6
v_lshlrev_b32 v52, 16, v10
v_and_b32 v53, 0xffff0000, v10
v_lshlrev_b32 v46, 16, v7
v_and_b32 v47, 0xffff0000, v7
v_lshlrev_b32 v54, 16, v11
v_and_b32 v55, 0xffff0000, v11
v_pk_fma_f32 v[40:41], v[40:41], v[28:29], v[28:29] op_sel:[0,0,1] op_sel_hi:[1,0,1]
v_pk_fma_f32 v[48:49], v[48:49], v[30:31], v[30:31] op_sel:[0,0,1] op_sel_hi:[1,0,1]
v_pk_fma_f32 v[42:43], v[42:43], v[28:29], v[28:29] op_sel:[0,0,1] op_sel_hi:[1,0,1]
v_pk_fma_f32 v[50:51], v[50:51], v[30:31], v[30:31] op_sel:[0,0,1] op_sel_hi:[1,0,1]
v_pk_fma_f32 v[44:45], v[44:45], v[28:29], v[28:29] op_sel:[0,0,1] op_sel_hi:[1,0,1]
v_pk_fma_f32 v[52:53], v[52:53], v[30:31], v[30:31] op_sel:[0,0,1] op_sel_hi:[1,0,1]
v_pk_fma_f32 v[46:47], v[46:47], v[28:29], v[28:29] op_sel:[0,0,1] op_sel_hi:[1,0,1]
v_pk_fma_f32 v[54:55], v[54:55], v[30:31], v[30:31] op_sel:[0,0,1] op_sel_hi:[1,0,1]
v_lshlrev_b32 v12, 16, v12
v_fma_f32 v12, v12, v28, v29
s_and_b32 s73, s66, 31
s_lshr_b32 s73, s73, 1
s_and_b32 s74, s66, 1
s_lshl_b32 s74, s74, 6
s_lshr_b32 s76, s66, 5
s_add_u32 s74, s74, s76
s_cmp_eq_u32 s73, s63
s_cselect_b32 s74, s74, 999
v_cmp_eq_u32 s[6:7], s74, v20
s_sub_u32 s75, 2048, s66
s_and_b32 s75, s75, 2047
s_and_b32 s73, s75, 31
s_lshr_b32 s73, s73, 1
s_and_b32 s74, s75, 1
s_lshl_b32 s74, s74, 6
s_lshr_b32 s76, s75, 5
s_add_u32 s74, s74, s76
s_cmp_eq_u32 s73, s63
s_cselect_b32 s74, s74, 999
v_cmp_eq_u32 s[8:9], s74, v20
s_waitcnt lgkmcnt(0)
v_pk_add_f32 v[48:49], v[48:49], v[38:39] op_sel:[0,1] op_sel_hi:[1,0]
v_pk_add_f32 v[50:51], v[50:51], v[36:37] op_sel:[0,1] op_sel_hi:[1,0]
v_pk_add_f32 v[52:53], v[52:53], v[34:35] op_sel:[0,1] op_sel_hi:[1,0]
v_pk_add_f32 v[54:55], v[54:55], v[32:33] op_sel:[0,1] op_sel_hi:[1,0]
s_cmp_lg_u32 s64, 0
s_cbranch_scc1 P2_fb
v_cmp_eq_u32 vcc, 0, v21
v_add_f32 v12, v12, v32
v_mov_b32 v24, 0
v_cndmask_b32 v32, v32, v24, vcc
P2_fb:
v_pk_add_f32 v[40:41], v[40:41], v[32:33]
v_pk_add_f32 v[42:43], v[42:43], v[34:35]
v_pk_add_f32 v[44:45], v[44:45], v[36:37]
v_pk_add_f32 v[46:47], v[46:47], v[38:39]
v_cvt_pk_bf16_f32 v56, v40, v41
v_cvt_pk_bf16_f32 v57, v42, v43
v_cvt_pk_bf16_f32 v58, v44, v45
v_cvt_pk_bf16_f32 v59, v46, v47
s_not_b64 exec, s[6:7]
buffer_store_dwordx4 v[56:59], v13, s[52:55], 0 offen sc1
s_mov_b64 exec, -1
v_cvt_pk_bf16_f32 v60, v48, v49
v_cvt_pk_bf16_f32 v61, v50, v51
v_cvt_pk_bf16_f32 v62, v52, v53
v_cvt_pk_bf16_f32 v63, v54, v55
s_not_b64 exec, s[8:9]
s_cmp_lg_u32 s64, 0
s_cbranch_scc1 P2_st
v_cvt_pk_bf16_f32 v24, v12, v12
v_cmp_eq_u32 vcc, 0, v21
s_mov_b64 s[84:85], exec
s_and_b64 exec, exec, vcc
buffer_store_dwordx3 v[60:62], v14, s[52:55], 0 offen sc1
buffer_store_short v63, v14, s[52:55], 0 offen offset:12 sc1
s_mov_b64 exec, -1
v_cvt_pk_bf16_f32 v24, v12, v12
v_cmp_eq_u32 vcc, 0, v21
s_andn2_b64 exec, vcc, s[6:7]
buffer_store_short v24, v13, s[52:55], 0 offen offset:576 sc1
s_andn2_b64 exec, s[84:85], vcc
P2_st:
buffer_store_dwordx4 v[60:63], v14, s[52:55], 0 offen sc1
s_mov_b64 exec, -1
v_lshlrev_b32 v24, 5, v21
v_sub_u32 v25, 96, v24
s_mov_b64 exec, s[6:7]
ds_write_b128 v24, v[40:43] offset:34816
ds_write_b128 v24, v[44:47] offset:34832
s_mov_b64 exec, s[8:9]
ds_write_b128 v25, v[48:51] offset:34944
ds_write_b128 v25, v[52:55] offset:34960
s_mov_b64 exec, -1
v_cmp_eq_u32 vcc, 0, v21
v_mov_b32 v25, 35072
s_and_b64 exec, vcc, s[6:7]
ds_write_b32 v25, v12
s_mov_b64 exec, -1
s_waitcnt lgkmcnt(0)
s_barrier
s_branch END
MOE:
s_sub_u32 s60, s2, 128
s_add_u32 s73, s60, 0
s_and_b32 s73, s73, 7
s_and_b32 s60, s60, 0xf8
s_or_b32 s60, s60, s73
s_mov_b32 s36, s18
s_mov_b32 s37, s19
s_mov_b32 s38, 5308416
s_mov_b32 s39, 0x20000
s_mov_b32 s40, s20
s_mov_b32 s41, s21
s_mov_b32 s42, 5308416
s_mov_b32 s43, 0x20000
s_mov_b32 s56, s22
s_mov_b32 s57, s23
s_mov_b32 s58, 5308416
s_mov_b32 s59, 0x20000
s_mov_b32 s86, 0
s_mov_b32 s87, 9216
s_mov_b32 s88, 147456
s_mov_b32 s89, 156672
s_mov_b32 s90, 294912
s_mov_b32 s91, 304128
s_mov_b32 s92, 442368
s_mov_b32 s93, 451584
v_lshrrev_b32 v20, 3, v1
v_lshlrev_b32 v21, 1, v20
s_lshl_b32 s73, s30, 6
v_add_u32 v21, s73, v21
v_mul_u32_u24 v21, 9216, v21
v_and_b32 v22, 7, v1
v_lshlrev_b32 v22, 4, v22
s_lshl_b32 s73, s60, 7
v_add_u32 v22, s73, v22
v_add_u32 v21, v21, v22
buffer_load_dwordx4 v[32:35], v21, s[36:39], s86 offen
buffer_load_dwordx4 v[36:39], v21, s[36:39], s87 offen
buffer_load_dwordx4 v[40:43], v21, s[36:39], s88 offen
buffer_load_dwordx4 v[44:47], v21, s[36:39], s89 offen
buffer_load_dwordx4 v[48:51], v21, s[36:39], s90 offen
buffer_load_dwordx4 v[52:55], v21, s[36:39], s91 offen
buffer_load_dwordx4 v[56:59], v21, s[36:39], s92 offen
buffer_load_dwordx4 v[60:63], v21, s[36:39], s93 offen
buffer_load_dwordx4 v[64:67], v21, s[40:43], s86 offen
buffer_load_dwordx4 v[68:71], v21, s[40:43], s87 offen
buffer_load_dwordx4 v[72:75], v21, s[40:43], s88 offen
buffer_load_dwordx4 v[76:79], v21, s[40:43], s89 offen
buffer_load_dwordx4 v[80:83], v21, s[40:43], s90 offen
buffer_load_dwordx4 v[84:87], v21, s[40:43], s91 offen
buffer_load_dwordx4 v[88:91], v21, s[40:43], s92 offen
buffer_load_dwordx4 v[92:95], v21, s[40:43], s93 offen
v_mul_u32_u24 v22, 911, v0
v_lshrrev_b32 v16, 16, v22
v_mul_u32_u24 v23, 72, v16
v_sub_u32 v17, v0, v23
v_mul_u32_u24 v23, 9216, v16
v_lshlrev_b32 v24, 4, v17
v_add_u32 v23, v23, v24
s_mul_i32 s73, s60, 73728
s_add_u32 s74, s73, 4608
s_mov_b32 s86, s73
s_mov_b32 s87, s74
s_mov_b32 s75, 0x05040100
s_mov_b32 s76, 0x07060302
s_waitcnt vmcnt(14)
v_perm_b32 v96, v36, v32, s75
v_perm_b32 v100, v36, v32, s76
v_perm_b32 v104, v37, v33, s75
v_perm_b32 v108, v37, v33, s76
v_perm_b32 v112, v38, v34, s75
v_perm_b32 v116, v38, v34, s76
v_perm_b32 v120, v39, v35, s75
v_perm_b32 v124, v39, v35, s76
s_waitcnt vmcnt(12)
v_perm_b32 v97, v44, v40, s75
v_perm_b32 v101, v44, v40, s76
v_perm_b32 v105, v45, v41, s75
v_perm_b32 v109, v45, v41, s76
v_perm_b32 v113, v46, v42, s75
v_perm_b32 v117, v46, v42, s76
v_perm_b32 v121, v47, v43, s75
v_perm_b32 v125, v47, v43, s76
s_waitcnt vmcnt(10)
v_perm_b32 v98, v52, v48, s75
v_perm_b32 v102, v52, v48, s76
v_perm_b32 v106, v53, v49, s75
v_perm_b32 v110, v53, v49, s76
v_perm_b32 v114, v54, v50, s75
v_perm_b32 v118, v54, v50, s76
v_perm_b32 v122, v55, v51, s75
v_perm_b32 v126, v55, v51, s76
s_waitcnt vmcnt(8)
v_perm_b32 v99, v60, v56, s75
v_perm_b32 v103, v60, v56, s76
v_perm_b32 v107, v61, v57, s75
v_perm_b32 v111, v61, v57, s76
v_perm_b32 v115, v62, v58, s75
v_perm_b32 v119, v62, v58, s76
v_perm_b32 v123, v63, v59, s75
v_perm_b32 v127, v63, v59, s76
s_waitcnt vmcnt(6)
v_perm_b32 v128, v68, v64, s75
v_perm_b32 v132, v68, v64, s76
v_perm_b32 v136, v69, v65, s75
v_perm_b32 v140, v69, v65, s76
v_perm_b32 v144, v70, v66, s75
v_perm_b32 v148, v70, v66, s76
v_perm_b32 v152, v71, v67, s75
v_perm_b32 v156, v71, v67, s76
s_waitcnt vmcnt(4)
v_perm_b32 v129, v76, v72, s75
v_perm_b32 v133, v76, v72, s76
v_perm_b32 v137, v77, v73, s75
v_perm_b32 v141, v77, v73, s76
v_perm_b32 v145, v78, v74, s75
v_perm_b32 v149, v78, v74, s76
v_perm_b32 v153, v79, v75, s75
v_perm_b32 v157, v79, v75, s76
s_waitcnt vmcnt(2)
v_perm_b32 v130, v84, v80, s75
v_perm_b32 v134, v84, v80, s76
v_perm_b32 v138, v85, v81, s75
v_perm_b32 v142, v85, v81, s76
v_perm_b32 v146, v86, v82, s75
v_perm_b32 v150, v86, v82, s76
v_perm_b32 v154, v87, v83, s75
v_perm_b32 v158, v87, v83, s76
s_waitcnt vmcnt(0)
v_perm_b32 v131, v92, v88, s75
v_perm_b32 v135, v92, v88, s76
v_perm_b32 v139, v93, v89, s75
v_perm_b32 v143, v93, v89, s76
v_perm_b32 v147, v94, v90, s75
v_perm_b32 v151, v94, v90, s76
v_perm_b32 v155, v95, v91, s75
v_perm_b32 v159, v95, v91, s76
buffer_load_dwordx4 v[32:35], v23, s[56:59], s86 offen offset:0
buffer_load_dwordx4 v[36:39], v23, s[56:59], s86 offen offset:1152
buffer_load_dwordx4 v[40:43], v23, s[56:59], s86 offen offset:2304
buffer_load_dwordx4 v[44:47], v23, s[56:59], s86 offen offset:3456
buffer_load_dwordx4 v[48:51], v23, s[56:59], s87 offen offset:0
buffer_load_dwordx4 v[52:55], v23, s[56:59], s87 offen offset:1152
buffer_load_dwordx4 v[56:59], v23, s[56:59], s87 offen offset:2304
buffer_load_dwordx4 v[60:63], v23, s[56:59], s87 offen offset:3456
s_cmp_lg_u32 s30, 0
s_cbranch_scc1 MOE_nw0
v_mov_b32 v20, 0
s_mov_b32 s77, 40000
MOE_pn_loop:
buffer_load_dword v21, v20, s[48:51], 0 offen sc1
s_waitcnt vmcnt(0)
v_readfirstlane_b32 s65, v21
s_sub_u32 s77, s77, 1
s_cmp_lg_u32 s65, 0
s_cbranch_scc1 MOE_pn_done
s_cmp_lg_u32 s77, 0
s_cbranch_scc1 MOE_pn_loop
MOE_pn_done:
s_and_b32 s73, s60, 7
s_lshl_b32 s73, s73, 13
s_add_u32 s73, s73, 3014656
v_lshlrev_b32 v20, 7, v1
v_add_u32 v20, s73, v20
s_mov_b32 s77, 40000
MOE_pc_loop:
buffer_load_dwordx4 v[22:25], v20, s[44:47], 0 offen sc1
s_waitcnt vmcnt(0)
v_cmp_ne_u32 vcc, s65, v22
s_sub_u32 s77, s77, 1
s_cbranch_vccz MOE_pc_done
s_mov_b64 exec, vcc
s_cmp_lg_u32 s77, 0
s_cbranch_scc1 MOE_pc_loop
MOE_pc_done:
s_mov_b64 exec, -1
v_mov_b32 v26, v23
s_nop 1
v_max_u32_dpp v26, v26, v26 row_shr:1 row_mask:0xf bank_mask:0xf bound_ctrl:0
s_nop 1
v_max_u32_dpp v26, v26, v26 row_shr:2 row_mask:0xf bank_mask:0xf bound_ctrl:0
s_nop 1
v_max_u32_dpp v26, v26, v26 row_shr:4 row_mask:0xf bank_mask:0xf bound_ctrl:0
s_nop 1
v_max_u32_dpp v26, v26, v26 row_shr:8 row_mask:0xf bank_mask:0xf bound_ctrl:0
s_nop 1
v_readlane_b32 s73, v26, 15
v_readlane_b32 s74, v26, 31
v_readlane_b32 s75, v26, 47
v_readlane_b32 s76, v26, 63
s_max_u32 s73, s73, s74
s_max_u32 s75, s75, s76
s_max_u32 s67, s73, s75
s_bfe_u32 s73, s67, 0x5000b
s_lshl_b32 s73, s73, 6
s_and_b32 s74, s67, 63
s_or_b32 s66, s73, s74
v_readlane_b32 s75, v24, s74
v_readlane_b32 s76, v25, s74
s_mul_i32 s73, s66, 1152
v_lshlrev_b32 v20, 4, v1
v_lshlrev_b32 v21, 2, v1
buffer_load_dwordx4 v[4:7], v20, s[32:35], s73 offen
s_mov_b32 exec_hi, 0
buffer_load_dword v8, v21, s[32:35], s73 offen offset:1024
s_mov_b32 exec_hi, -1
v_mov_b32 v22, 161920
v_mov_b32 v24, s65
ds_write_b32 v22, v24 offset:8
v_mov_b32 v22, s76
v_mov_b32 v23, s75
s_waitcnt vmcnt(0)
v_lshlrev_b32 v10, 16, v4
v_and_b32 v11, 0xffff0000, v4
v_sub_f32 v10, v10, v22
v_sub_f32 v11, v11, v22
v_cvt_pk_bf16_f32 v4, v10, v11
v_lshlrev_b32 v10, 16, v4
v_and_b32 v11, 0xffff0000, v4
v_mul_f32 v10, v10, v23
v_mul_f32 v11, v11, v23
v_cvt_pk_bf16_f32 v4, v10, v11
v_lshlrev_b32 v10, 16, v5
v_and_b32 v11, 0xffff0000, v5
v_sub_f32 v10, v10, v22
v_sub_f32 v11, v11, v22
v_cvt_pk_bf16_f32 v5, v10, v11
v_lshlrev_b32 v10, 16, v5
v_and_b32 v11, 0xffff0000, v5
v_mul_f32 v10, v10, v23
v_mul_f32 v11, v11, v23
v_cvt_pk_bf16_f32 v5, v10, v11
v_lshlrev_b32 v10, 16, v6
v_and_b32 v11, 0xffff0000, v6
v_sub_f32 v10, v10, v22
v_sub_f32 v11, v11, v22
v_cvt_pk_bf16_f32 v6, v10, v11
v_lshlrev_b32 v10, 16, v6
v_and_b32 v11, 0xffff0000, v6
v_mul_f32 v10, v10, v23
v_mul_f32 v11, v11, v23
v_cvt_pk_bf16_f32 v6, v10, v11
v_lshlrev_b32 v10, 16, v7
v_and_b32 v11, 0xffff0000, v7
v_sub_f32 v10, v10, v22
v_sub_f32 v11, v11, v22
v_cvt_pk_bf16_f32 v7, v10, v11
v_lshlrev_b32 v10, 16, v7
v_and_b32 v11, 0xffff0000, v7
v_mul_f32 v10, v10, v23
v_mul_f32 v11, v11, v23
v_cvt_pk_bf16_f32 v7, v10, v11
v_lshlrev_b32 v10, 16, v8
v_and_b32 v11, 0xffff0000, v8
v_sub_f32 v10, v10, v22
v_sub_f32 v11, v11, v22
v_cvt_pk_bf16_f32 v8, v10, v11
v_lshlrev_b32 v10, 16, v8
v_and_b32 v11, 0xffff0000, v8
v_mul_f32 v10, v10, v23
v_mul_f32 v11, v11, v23
v_cvt_pk_bf16_f32 v8, v10, v11
ds_write_b128 v20, v[4:7] offset:28672
s_mov_b32 exec_hi, 0
ds_write_b32 v21, v8 offset:29696
s_mov_b32 exec_hi, -1
MOE_nw0:
v_lshrrev_b32 v22, 4, v1
v_and_b32 v21, 1, v1
v_lshl_add_u32 v22, v22, 1, v21
s_lshl_b32 s74, s30, 5
v_add_u32 v22, s74, v22
v_lshlrev_b32 v22, 2, v22
v_and_b32 v21, 7, v1
v_lshlrev_b32 v21, 5, v21
s_lshl_b32 s73, s30, 9
v_add_u32 v21, s73, v21
s_waitcnt lgkmcnt(0)
s_barrier
ds_read_b32 v24, v22 offset:28672
ds_read_b32 v25, v22 offset:28704
ds_read_b32 v26, v22 offset:28736
ds_read_b32 v27, v22 offset:28768
v_mov_b32 v20, 161920
ds_read_b32 v9, v20 offset:8
s_waitcnt lgkmcnt(1)
v_mfma_f32_16x16x32_bf16 v[64:67], v[24:27], v[96:99], 0
v_mfma_f32_16x16x32_bf16 v[68:71], v[24:27], v[100:103], 0
v_mfma_f32_16x16x32_bf16 v[72:75], v[24:27], v[104:107], 0
v_mfma_f32_16x16x32_bf16 v[76:79], v[24:27], v[108:111], 0
v_mfma_f32_16x16x32_bf16 v[80:83], v[24:27], v[112:115], 0
v_mfma_f32_16x16x32_bf16 v[84:87], v[24:27], v[116:119], 0
v_mfma_f32_16x16x32_bf16 v[88:91], v[24:27], v[120:123], 0
v_mfma_f32_16x16x32_bf16 v[92:95], v[24:27], v[124:127], 0
s_nop 7
v_add_f32_dpp v96, v65, v64 row_ror:8 row_mask:0xf bank_mask:0xf
v_add_f32_dpp v97, v69, v68 row_ror:8 row_mask:0xf bank_mask:0xf
v_add_f32_dpp v98, v73, v72 row_ror:8 row_mask:0xf bank_mask:0xf
v_add_f32_dpp v99, v77, v76 row_ror:8 row_mask:0xf bank_mask:0xf
v_add_f32_dpp v100, v81, v80 row_ror:8 row_mask:0xf bank_mask:0xf
v_add_f32_dpp v101, v85, v84 row_ror:8 row_mask:0xf bank_mask:0xf
v_add_f32_dpp v102, v89, v88 row_ror:8 row_mask:0xf bank_mask:0xf
v_add_f32_dpp v103, v93, v92 row_ror:8 row_mask:0xf bank_mask:0xf
v_mfma_f32_16x16x32_bf16 v[64:67], v[24:27], v[128:131], 0
v_mfma_f32_16x16x32_bf16 v[68:71], v[24:27], v[132:135], 0
v_mfma_f32_16x16x32_bf16 v[72:75], v[24:27], v[136:139], 0
v_mfma_f32_16x16x32_bf16 v[76:79], v[24:27], v[140:143], 0
v_mfma_f32_16x16x32_bf16 v[80:83], v[24:27], v[144:147], 0
v_mfma_f32_16x16x32_bf16 v[84:87], v[24:27], v[148:151], 0
v_mfma_f32_16x16x32_bf16 v[88:91], v[24:27], v[152:155], 0
v_mfma_f32_16x16x32_bf16 v[92:95], v[24:27], v[156:159], 0
s_nop 7
v_add_f32_dpp v104, v65, v64 row_ror:8 row_mask:0xf bank_mask:0xf
v_add_f32_dpp v105, v69, v68 row_ror:8 row_mask:0xf bank_mask:0xf
v_add_f32_dpp v106, v73, v72 row_ror:8 row_mask:0xf bank_mask:0xf
v_add_f32_dpp v107, v77, v76 row_ror:8 row_mask:0xf bank_mask:0xf
v_add_f32_dpp v108, v81, v80 row_ror:8 row_mask:0xf bank_mask:0xf
v_add_f32_dpp v109, v85, v84 row_ror:8 row_mask:0xf bank_mask:0xf
v_add_f32_dpp v110, v89, v88 row_ror:8 row_mask:0xf bank_mask:0xf
v_add_f32_dpp v111, v93, v92 row_ror:8 row_mask:0xf bank_mask:0xf
s_mov_b64 exec, 0xff
ds_write_b128 v21, v[96:99] offset:0
ds_write_b128 v21, v[100:103] offset:16
ds_write_b128 v21, v[104:107] offset:256
ds_write_b128 v21, v[108:111] offset:272
s_mov_b64 exec, -1
s_waitcnt lgkmcnt(0)
s_barrier
v_lshlrev_b32 v20, 2, v1
ds_read_b32 v96, v20 offset:0
ds_read_b32 v112, v20 offset:256
ds_read_b32 v97, v20 offset:512
ds_read_b32 v113, v20 offset:768
ds_read_b32 v98, v20 offset:1024
ds_read_b32 v114, v20 offset:1280
ds_read_b32 v99, v20 offset:1536
ds_read_b32 v115, v20 offset:1792
ds_read_b32 v100, v20 offset:2048
ds_read_b32 v116, v20 offset:2304
ds_read_b32 v101, v20 offset:2560
ds_read_b32 v117, v20 offset:2816
ds_read_b32 v102, v20 offset:3072
ds_read_b32 v118, v20 offset:3328
ds_read_b32 v103, v20 offset:3584
ds_read_b32 v119, v20 offset:3840
ds_read_b32 v104, v20 offset:4096
ds_read_b32 v120, v20 offset:4352
s_lshl_b32 s73, s30, 7
s_add_u32 s73, s73, 4608
v_lshlrev_b32 v24, 1, v1
v_add_u32 v24, s73, v24
v_lshlrev_b32 v25, 4, v16
v_add_u32 v25, s73, v25
s_mov_b32 s75, 0x05040100
s_mov_b32 s76, 0x07060302
s_waitcnt vmcnt(6)
v_perm_b32 v64, v36, v32, s75
v_perm_b32 v36, v36, v32, s76
v_perm_b32 v32, v37, v33, s75
v_perm_b32 v37, v37, v33, s76
v_perm_b32 v33, v38, v34, s75
v_perm_b32 v38, v38, v34, s76
v_perm_b32 v34, v39, v35, s75
v_perm_b32 v39, v39, v35, s76
s_waitcnt vmcnt(4)
v_perm_b32 v35, v44, v40, s75
v_perm_b32 v44, v44, v40, s76
v_perm_b32 v40, v45, v41, s75
v_perm_b32 v45, v45, v41, s76
v_perm_b32 v41, v46, v42, s75
v_perm_b32 v46, v46, v42, s76
v_perm_b32 v42, v47, v43, s75
v_perm_b32 v47, v47, v43, s76
s_waitcnt vmcnt(2)
v_perm_b32 v43, v52, v48, s75
v_perm_b32 v52, v52, v48, s76
v_perm_b32 v48, v53, v49, s75
v_perm_b32 v53, v53, v49, s76
v_perm_b32 v49, v54, v50, s75
v_perm_b32 v54, v54, v50, s76
v_perm_b32 v50, v55, v51, s75
v_perm_b32 v55, v55, v51, s76
s_waitcnt vmcnt(0)
v_perm_b32 v51, v60, v56, s75
v_perm_b32 v60, v60, v56, s76
v_perm_b32 v56, v61, v57, s75
v_perm_b32 v61, v61, v57, s76
v_perm_b32 v57, v62, v58, s75
v_perm_b32 v62, v62, v58, s76
v_perm_b32 v58, v63, v59, s75
v_perm_b32 v63, v63, v59, s76
s_waitcnt lgkmcnt(0)
v_add_f32 v96, v96, v97
v_add_f32 v112, v112, v113
v_add_f32 v98, v98, v99
v_add_f32 v114, v114, v115
v_add_f32 v100, v100, v101
v_add_f32 v116, v116, v117
v_add_f32 v102, v102, v103
v_add_f32 v118, v118, v119
v_add_f32 v96, v96, v104
v_add_f32 v112, v112, v120
v_add_f32 v98, v98, v100
v_add_f32 v114, v114, v116
v_add_f32 v96, v96, v102
v_add_f32 v112, v112, v118
v_add_f32 v22, v96, v98
v_add_f32 v23, v112, v114
v_cvt_pk_bf16_f32 v22, v22, v23
v_and_b32 v23, 0xffff0000, v22
v_lshlrev_b32 v22, 16, v22
v_mul_f32 v26, 0xbfb8aa3b, v22
v_exp_f32 v26, v26
s_nop 0
v_add_f32 v26, 1.0, v26
v_rcp_f32 v26, v26
s_nop 0
v_mul_f32 v22, v22, v26
v_cvt_pk_bf16_f32 v22, v22, v22
v_lshlrev_b32 v22, 16, v22
v_mul_f32 v22, v22, v23
v_cvt_pk_bf16_f32 v22, v22, v22
ds_write_b16 v24, v22
s_waitcnt lgkmcnt(0)
ds_read_b128 v[28:31], v25
s_waitcnt lgkmcnt(0)
v_dot2_f32_bf16 v128, v64, v28, 0
v_dot2_f32_bf16 v129, v36, v28, 0
v_dot2_f32_bf16 v130, v32, v28, 0
v_dot2_f32_bf16 v131, v37, v28, 0
v_dot2_f32_bf16 v132, v33, v28, 0
v_dot2_f32_bf16 v133, v38, v28, 0
v_dot2_f32_bf16 v134, v34, v28, 0
v_dot2_f32_bf16 v135, v39, v28, 0
v_dot2_f32_bf16 v128, v35, v29, v128
v_dot2_f32_bf16 v129, v44, v29, v129
v_dot2_f32_bf16 v130, v40, v29, v130
v_dot2_f32_bf16 v131, v45, v29, v131
v_dot2_f32_bf16 v132, v41, v29, v132
v_dot2_f32_bf16 v133, v46, v29, v133
v_dot2_f32_bf16 v134, v42, v29, v134
v_dot2_f32_bf16 v135, v47, v29, v135
v_dot2_f32_bf16 v128, v43, v30, v128
v_dot2_f32_bf16 v129, v52, v30, v129
v_dot2_f32_bf16 v130, v48, v30, v130
v_dot2_f32_bf16 v131, v53, v30, v131
v_dot2_f32_bf16 v132, v49, v30, v132
v_dot2_f32_bf16 v133, v54, v30, v133
v_dot2_f32_bf16 v134, v50, v30, v134
v_dot2_f32_bf16 v135, v55, v30, v135
v_dot2_f32_bf16 v128, v51, v31, v128
v_dot2_f32_bf16 v129, v60, v31, v129
v_dot2_f32_bf16 v130, v56, v31, v130
v_dot2_f32_bf16 v131, v61, v31, v131
v_dot2_f32_bf16 v132, v57, v31, v132
v_dot2_f32_bf16 v133, v62, v31, v133
v_dot2_f32_bf16 v134, v58, v31, v134
v_dot2_f32_bf16 v135, v63, v31, v135
s_nop 2
v_mul_u32_u24 v26, 2432, v16
v_lshl_add_u32 v26, v17, 5, v26
v_add_u32 v27, 124, v26
v_cmp_lt_u32 vcc, 36, v17
v_cmp_le_u32 s[84:85], 36, v17
s_nop 1
v_cndmask_b32 v20, v26, v27, vcc
v_cndmask_b32 v21, v26, v27, s[84:85]
ds_write_b32 v20, v128 offset:8192
v_add_u32 v21, 8192, v21
ds_write2_b32 v21, v129, v130 offset0:1 offset1:2
ds_write2_b32 v21, v131, v132 offset0:3 offset1:4
ds_write2_b32 v21, v133, v134 offset0:5 offset1:6
ds_write_b32 v21, v135 offset:28
s_waitcnt lgkmcnt(0)
s_barrier
v_mov_b32 v20, 152
v_cmp_gt_u32 vcc, v20, v0
s_and_saveexec_b64 s[84:85], vcc
s_cbranch_execz END
v_lshlrev_b32 v20, 4, v0
ds_read_b128 v[32:35], v20 offset:8192
ds_read_b128 v[36:39], v20 offset:10624
ds_read_b128 v[40:43], v20 offset:13056
ds_read_b128 v[44:47], v20 offset:15488
ds_read_b128 v[48:51], v20 offset:17920
ds_read_b128 v[52:55], v20 offset:20352
ds_read_b128 v[56:59], v20 offset:22784
ds_read_b128 v[60:63], v20 offset:25216
s_mov_b32 s86, 0x07060500
s_mov_b32 s87, 0x07060501
s_mov_b32 s88, 0x07060502
s_mov_b32 s89, 0x07060503
s_mul_i32 s73, s60, 2432
s_add_u32 s73, s73, 2506752
s_waitcnt lgkmcnt(6)
v_pk_add_f32 v[32:33], v[32:33], v[36:37]
v_pk_add_f32 v[34:35], v[34:35], v[38:39]
s_waitcnt lgkmcnt(5)
v_pk_add_f32 v[32:33], v[32:33], v[40:41]
v_pk_add_f32 v[34:35], v[34:35], v[42:43]
s_waitcnt lgkmcnt(4)
v_pk_add_f32 v[32:33], v[32:33], v[44:45]
v_pk_add_f32 v[34:35], v[34:35], v[46:47]
s_waitcnt lgkmcnt(3)
v_pk_add_f32 v[32:33], v[32:33], v[48:49]
v_pk_add_f32 v[34:35], v[34:35], v[50:51]
s_waitcnt lgkmcnt(2)
v_pk_add_f32 v[32:33], v[32:33], v[52:53]
v_pk_add_f32 v[34:35], v[34:35], v[54:55]
s_waitcnt lgkmcnt(1)
v_pk_add_f32 v[32:33], v[32:33], v[56:57]
v_pk_add_f32 v[34:35], v[34:35], v[58:59]
s_waitcnt lgkmcnt(0)
v_pk_add_f32 v[32:33], v[32:33], v[60:61]
v_pk_add_f32 v[34:35], v[34:35], v[62:63]
s_nop 0
v_perm_b32 v24, v32, v9, s86
v_perm_b32 v25, v33, v9, s87
v_perm_b32 v26, v34, v9, s88
v_perm_b32 v27, v35, v9, s89
buffer_store_dwordx4 v[24:27], v20, s[44:47], s73 offen sc1
s_branch END
END:
ENDX:
s_endpgm
.section .rodata,"a"
.p2align 6
.amdhsa_kernel parallel_sum__spectral_fnet__moe_arch_mod__prompt_kernel
  .amdhsa_next_free_vgpr 168
  .amdhsa_next_free_sgpr 102
  .amdhsa_accum_offset 168
  .amdhsa_group_segment_fixed_size 0
  .amdhsa_kernarg_size 104
  .amdhsa_user_sgpr_count 2
  .amdhsa_user_sgpr_kernarg_segment_ptr 1
  .amdhsa_system_sgpr_workgroup_id_x 1
.end_amdhsa_kernel
```
